```python
import torch

def _softmax(x, axis=-1):
    return torch.softmax(x, dim=axis)
def _gelu(x):
    return torch.nn.functional.gelu(x, approximate="tanh")
def _silu(x):
    return torch.nn.functional.silu(x)
def _sigmoid(x):
    return torch.sigmoid(x)
def _layernorm(x, axis=-1, eps=1e-5):
    m = x.mean(dim=axis, keepdim=True)
    v = x.var(dim=axis, keepdim=True, unbiased=False)
    return (x - m) / torch.sqrt(v + eps)
def _scatter_add(tgt, idx, src, axis=0):
    return tgt.clone().index_add_(axis, idx, src)
def _segment_sum(src, seg, n):
    out = torch.zeros((n,) + src.shape[1:], dtype=src.dtype)
    return out.index_add_(0, seg, src)
def _pad(x, pw):
    flat = tuple(v for pair in reversed(pw) for v in pair)
    return torch.nn.functional.pad(x, flat)

kernel_name = 'gated_mix__sliding_block_cached__dense_activation_silu__decode'

def setup_inputs():

    _w = (lambda a: (lambda t: t.to(torch.bfloat16) if t.is_floating_point() else t)(torch.as_tensor(a)))
    def _A_setup():
        B, Sq, D = 8, 1, 448
        Hq, Hkv, Sk, Dh = 16, 8, 4096, 256
        assert Hq % Hkv == 0, (Hq, Hkv)
        return {
            "x": _w((lambda *s: torch.randn(*s, dtype=torch.bfloat16) * 0.2)(B, Sq, D)),
            "k_cache": _w((lambda *s: torch.randn(*s, dtype=torch.bfloat16) * 3.2)(B, Hkv, Sk, Dh)),
            "v_cache": _w((lambda *s: torch.randn(*s, dtype=torch.bfloat16) * 3.2)(B, Hkv, Sk, Dh)),
            "wq": _w((lambda *s: torch.randn(*s, dtype=torch.bfloat16) * 3.2)(D, Hq * Dh) * (D ** -0.5)),
            "wo": _w((lambda *s: torch.randn(*s, dtype=torch.bfloat16) * 3.2)(Hq * Dh, D) * ((Hq * Dh) ** -0.5)),
        }
    _A_in = _A_setup()

    def _B_setup():
        B, S, D, F = 8, 1, 448, 1792
        return {
            "x": _w((lambda *s: torch.randn(*s, dtype=torch.bfloat16) * 0.2)(B, S, D)),
            "w1": _w((lambda *s: torch.randn(*s, dtype=torch.bfloat16) * 3.2)(D, F) * (D ** -0.5)),
            "w2": _w((lambda *s: torch.randn(*s, dtype=torch.bfloat16) * 3.2)(F, D) * (F ** -0.5)),
        }
    _B_in = _B_setup()

    return {
        "A_x": _A_in["x"],
        "A_k_cache": _A_in["k_cache"],
        "A_v_cache": _A_in["v_cache"],
        "A_wq": _A_in["wq"],
        "A_wo": _A_in["wo"],
        "B_x": _B_in["x"],
        "B_w1": _B_in["w1"],
        "B_w2": _B_in["w2"],
        "gate_w": _w((lambda *s: torch.randn(*s, dtype=torch.bfloat16) * 0.2)(448) * 16.0),
    }

def reference(A_x, A_k_cache, A_v_cache, A_wq, A_wo, B_x, B_w1, B_w2, gate_w):
    def _A_ref(x, k_cache, v_cache, wq, wo):
        B, Sq, D = x.shape
        Hq, Dh = 16, 256
        Hkv, Sk = k_cache.shape[1], k_cache.shape[2]
        W = min(4096, max(256, Sk // 4))
        rep = Hq // Hkv
        q = (lambda x, *d: x.permute(*d))((x @ wq).reshape(B, Sq, Hq, Dh), 0, 2, 1, 3)
        k = (lambda x, n, axis: torch.repeat_interleave(x, n, dim=axis))(k_cache[:, :, Sk - W:, :], rep, axis=1)
        v = (lambda x, n, axis: torch.repeat_interleave(x, n, dim=axis))(v_cache[:, :, Sk - W:, :], rep, axis=1)
        scores = torch.einsum("bhqd,bhkd->bhqk", q, k) * (Dh ** -0.5)
        p = _softmax(scores, axis=-1)
        o = torch.einsum("bhqk,bhkd->bhqd", p, v)
        return (lambda x, *d: x.permute(*d))(o, 0, 2, 1, 3).reshape(B, Sq, Hq * Dh) @ wo

    def _B_ref(x, w1, w2):
        h = torch.einsum("bsd,df->bsf", x, w1)
        h = _silu(h)
        out = torch.einsum("bsf,fd->bsd", h, w2)
        return out

    x = A_x
    g = _sigmoid((x * gate_w).sum(-1, keepdims=True))
    a = _A_ref(x, A_k_cache, A_v_cache, A_wq, A_wo)
    b = _B_ref(x, B_w1, B_w2)
    return g * a + (1 - g) * b
```

```asm
; @launch grid=(256,1,1) block=(512,1,1) lds=139264
.amdgcn_target "amdgcn-amd-amdhsa--gfx950"
.text
.globl gated_mix__sliding_block_cached__dense_activation_silu__decode_kernel
.p2align 8
.type gated_mix__sliding_block_cached__dense_activation_silu__decode_kernel,@function
gated_mix__sliding_block_cached__dense_activation_silu__decode_kernel:
    s_cmp_ge_u32 s2, 256
    s_cbranch_scc1 L_END
    s_load_dwordx16 s[4:19], s[0:1], 0
    s_load_dwordx8 s[20:27], s[0:1], 64
    v_lshrrev_b32 v1, 6, v0
    v_and_b32 v0, 63, v0
    s_and_b32 s28, s2, 7
    v_readfirstlane_b32 s3, v1
    s_bfe_u32 s29, s2, 0x30003
    s_lshr_b32 s30, s2, 6
    s_lshl_b32 s31, s30, 3
    s_add_u32 s31, s31, s28
    s_mov_b32 s52, 0x05040100
    s_mov_b32 s53, 0x07060302
    s_mov_b32 s54, 0
    s_mov_b32 s56, 0xff00ff00
    s_mov_b32 s57, 0xff00ff00
    s_cmp_ge_u32 s3, 4
    s_cbranch_scc1 L_X
    s_lshl_b32 s44, s29, 3
    s_add_u32 s44, s44, s28
    s_lshl_b32 s44, s44, 21
    s_add_u32 s44, s44, 0x180000
    s_lshl_b32 s45, s30, 17
    s_add_u32 s44, s44, s45
    s_lshl_b32 s58, s3, 15
    s_add_u32 s59, s44, s58
    s_add_u32 s58, s58, 8192
    s_lshr_b32 s45, s2, 3
    s_add_u32 s45, s45, s2
    s_lshl_b32 s46, s3, 3
    s_add_u32 s45, s45, s46
    v_lshrrev_b32 v1, 5, v0
    v_and_b32 v2, 31, v0
    v_xor_b32 v2, v2, v1
    v_lshlrev_b32 v2, 4, v2
    v_lshl_add_u32 v2, v1, 9, v2
    v_lshrrev_b32 v1, 3, v0
    v_lshlrev_b32 v4, 12, v1
    v_and_b32 v1, 7, v0
    v_lshl_add_u32 v4, v1, 4, v4
    s_lshl_b32 s46, s3, 7
    v_add_u32 v4, s46, v4
    v_mov_b32 v10, 0
    s_lshl_b32 s46, s3, 2
    v_mov_b32 v11, s46
    s_waitcnt lgkmcnt(0)
    s_mov_b32 s32, s6
    s_mov_b32 s33, s7
    s_mov_b32 s34, 134217728
    s_mov_b32 s35, 0x20000
    s_add_u32 s46, s45, 0
    s_and_b32 s46, s46, 31
    s_lshl_b32 s47, s46, 10
    s_add_u32 s48, s47, s59
    s_add_u32 m0, s47, s58
    s_lshl_b32 s49, s46, 5
    s_and_b32 s49, s49, 0xe0
    v_xor_b32 v3, s49, v2
    buffer_load_dwordx4 v3, s[32:35], s48 offen nt lds
    s_add_u32 s46, s45, 1
    s_and_b32 s46, s46, 31
    s_lshl_b32 s47, s46, 10
    s_add_u32 s48, s47, s59
    s_add_u32 m0, s47, s58
    s_lshl_b32 s49, s46, 5
    s_and_b32 s49, s49, 0xe0
    v_xor_b32 v3, s49, v2
    buffer_load_dwordx4 v3, s[32:35], s48 offen nt lds
    s_add_u32 s46, s45, 2
    s_and_b32 s46, s46, 31
    s_lshl_b32 s47, s46, 10
    s_add_u32 s48, s47, s59
    s_add_u32 m0, s47, s58
    s_lshl_b32 s49, s46, 5
    s_and_b32 s49, s49, 0xe0
    v_xor_b32 v3, s49, v2
    buffer_load_dwordx4 v3, s[32:35], s48 offen nt lds
    s_add_u32 s46, s45, 3
    s_and_b32 s46, s46, 31
    s_lshl_b32 s47, s46, 10
    s_add_u32 s48, s47, s59
    s_add_u32 m0, s47, s58
    s_lshl_b32 s49, s46, 5
    s_and_b32 s49, s49, 0xe0
    v_xor_b32 v3, s49, v2
    buffer_load_dwordx4 v3, s[32:35], s48 offen nt lds
    s_add_u32 s46, s45, 4
    s_and_b32 s46, s46, 31
    s_lshl_b32 s47, s46, 10
    s_add_u32 s48, s47, s59
    s_add_u32 m0, s47, s58
    s_lshl_b32 s49, s46, 5
    s_and_b32 s49, s49, 0xe0
    v_xor_b32 v3, s49, v2
    buffer_load_dwordx4 v3, s[32:35], s48 offen nt lds
    s_mov_b32 s36, s8
    s_mov_b32 s37, s9
    s_mov_b32 s38, 134217728
    s_mov_b32 s39, 0x20000
    s_mov_b32 s40, s26
    s_mov_b32 s41, s27
    s_mov_b32 s42, 536870912
    s_mov_b32 s43, 0x20000
    s_load_dword s50, s[26:27], 0
    s_waitcnt vmcnt(4)
    s_add_u32 s46, s45, 5
    s_and_b32 s46, s46, 31
    s_lshl_b32 s47, s46, 10
    s_add_u32 s48, s47, s59
    s_add_u32 m0, s47, s58
    s_lshl_b32 s49, s46, 5
    s_and_b32 s49, s49, 0xe0
    v_xor_b32 v3, s49, v2
    buffer_load_dwordx4 v3, s[32:35], s48 offen nt lds
    s_waitcnt vmcnt(4)
    s_add_u32 s46, s45, 6
    s_and_b32 s46, s46, 31
    s_lshl_b32 s47, s46, 10
    s_add_u32 s48, s47, s59
    s_add_u32 m0, s47, s58
    s_lshl_b32 s49, s46, 5
    s_and_b32 s49, s49, 0xe0
    v_xor_b32 v3, s49, v2
    buffer_load_dwordx4 v3, s[32:35], s48 offen nt lds
    s_waitcnt vmcnt(4)
    s_add_u32 s46, s45, 7
    s_and_b32 s46, s46, 31
    s_lshl_b32 s47, s46, 10
    s_add_u32 s48, s47, s59
    s_add_u32 m0, s47, s58
    s_lshl_b32 s49, s46, 5
    s_and_b32 s49, s49, 0xe0
    v_xor_b32 v3, s49, v2
    buffer_load_dwordx4 v3, s[32:35], s48 offen nt lds
    s_waitcnt vmcnt(4)
    s_add_u32 s46, s45, 8
    s_and_b32 s46, s46, 31
    s_lshl_b32 s47, s46, 10
    s_add_u32 s48, s47, s59
    s_add_u32 m0, s47, s58
    s_lshl_b32 s49, s46, 5
    s_and_b32 s49, s49, 0xe0
    v_xor_b32 v3, s49, v2
    buffer_load_dwordx4 v3, s[32:35], s48 offen nt lds
    s_barrier
    s_waitcnt vmcnt(4)
    s_add_u32 s46, s45, 9
    s_and_b32 s46, s46, 31
    s_lshl_b32 s47, s46, 10
    s_add_u32 s48, s47, s59
    s_add_u32 m0, s47, s58
    s_lshl_b32 s49, s46, 5
    s_and_b32 s49, s49, 0xe0
    v_xor_b32 v3, s49, v2
    buffer_load_dwordx4 v3, s[32:35], s48 offen nt lds
    s_waitcnt vmcnt(4)
    s_add_u32 s46, s45, 10
    s_and_b32 s46, s46, 31
    s_lshl_b32 s47, s46, 10
    s_add_u32 s48, s47, s59
    s_add_u32 m0, s47, s58
    s_lshl_b32 s49, s46, 5
    s_and_b32 s49, s49, 0xe0
    v_xor_b32 v3, s49, v2
    buffer_load_dwordx4 v3, s[32:35], s48 offen nt lds
    s_waitcnt vmcnt(4)
    s_add_u32 s46, s45, 11
    s_and_b32 s46, s46, 31
    s_lshl_b32 s47, s46, 10
    s_add_u32 s48, s47, s59
    s_add_u32 m0, s47, s58
    s_lshl_b32 s49, s46, 5
    s_and_b32 s49, s49, 0xe0
    v_xor_b32 v3, s49, v2
    buffer_load_dwordx4 v3, s[32:35], s48 offen nt lds
    s_waitcnt vmcnt(4)
    s_add_u32 s46, s45, 12
    s_and_b32 s46, s46, 31
    s_lshl_b32 s47, s46, 10
    s_add_u32 s48, s47, s59
    s_add_u32 m0, s47, s58
    s_lshl_b32 s49, s46, 5
    s_and_b32 s49, s49, 0xe0
    v_xor_b32 v3, s49, v2
    buffer_load_dwordx4 v3, s[32:35], s48 offen nt lds
    s_waitcnt vmcnt(4)
    s_add_u32 s46, s45, 13
    s_and_b32 s46, s46, 31
    s_lshl_b32 s47, s46, 10
    s_add_u32 s48, s47, s59
    s_add_u32 m0, s47, s58
    s_lshl_b32 s49, s46, 5
    s_and_b32 s49, s49, 0xe0
    v_xor_b32 v3, s49, v2
    buffer_load_dwordx4 v3, s[32:35], s48 offen nt lds
    s_waitcnt vmcnt(4)
    s_add_u32 s46, s45, 14
    s_and_b32 s46, s46, 31
    s_lshl_b32 s47, s46, 10
    s_add_u32 s48, s47, s59
    s_add_u32 m0, s47, s58
    s_lshl_b32 s49, s46, 5
    s_and_b32 s49, s49, 0xe0
    v_xor_b32 v3, s49, v2
    buffer_load_dwordx4 v3, s[32:35], s48 offen nt lds
    s_waitcnt vmcnt(4)
    s_add_u32 s46, s45, 15
    s_and_b32 s46, s46, 31
    s_lshl_b32 s47, s46, 10
    s_add_u32 s48, s47, s59
    s_add_u32 m0, s47, s58
    s_lshl_b32 s49, s46, 5
    s_and_b32 s49, s49, 0xe0
    v_xor_b32 v3, s49, v2
    buffer_load_dwordx4 v3, s[32:35], s48 offen nt lds
    s_waitcnt vmcnt(4)
    s_add_u32 s46, s45, 16
    s_and_b32 s46, s46, 31
    s_lshl_b32 s47, s46, 10
    s_add_u32 s48, s47, s59
    s_add_u32 m0, s47, s58
    s_lshl_b32 s49, s46, 5
    s_and_b32 s49, s49, 0xe0
    v_xor_b32 v3, s49, v2
    buffer_load_dwordx4 v3, s[32:35], s48 offen nt lds
    s_waitcnt vmcnt(4)
    s_add_u32 s46, s45, 17
    s_and_b32 s46, s46, 31
    s_lshl_b32 s47, s46, 10
    s_add_u32 s48, s47, s59
    s_add_u32 m0, s47, s58
    s_lshl_b32 s49, s46, 5
    s_and_b32 s49, s49, 0xe0
    v_xor_b32 v3, s49, v2
    buffer_load_dwordx4 v3, s[32:35], s48 offen nt lds
    s_waitcnt vmcnt(4)
    s_add_u32 s46, s45, 18
    s_and_b32 s46, s46, 31
    s_lshl_b32 s47, s46, 10
    s_add_u32 s48, s47, s59
    s_add_u32 m0, s47, s58
    s_lshl_b32 s49, s46, 5
    s_and_b32 s49, s49, 0xe0
    v_xor_b32 v3, s49, v2
    buffer_load_dwordx4 v3, s[32:35], s48 offen nt lds
    s_waitcnt vmcnt(4)
    s_add_u32 s46, s45, 19
    s_and_b32 s46, s46, 31
    s_lshl_b32 s47, s46, 10
    s_add_u32 s48, s47, s59
    s_add_u32 m0, s47, s58
    s_lshl_b32 s49, s46, 5
    s_and_b32 s49, s49, 0xe0
    v_xor_b32 v3, s49, v2
    buffer_load_dwordx4 v3, s[32:35], s48 offen nt lds
    s_waitcnt vmcnt(4)
    v_mov_b32 v9, 1
    ds_write_b32 v11, v9 offset:2560
    s_add_u32 s46, s45, 20
    s_and_b32 s46, s46, 31
    s_lshl_b32 s47, s46, 10
    s_add_u32 s48, s47, s59
    s_add_u32 m0, s47, s58
    s_lshl_b32 s49, s46, 5
    s_and_b32 s49, s49, 0xe0
    v_xor_b32 v3, s49, v2
    buffer_load_dwordx4 v3, s[32:35], s48 offen nt lds
    s_waitcnt vmcnt(4)
    s_add_u32 s46, s45, 21
    s_and_b32 s46, s46, 31
    s_lshl_b32 s47, s46, 10
    s_add_u32 s48, s47, s59
    s_add_u32 m0, s47, s58
    s_lshl_b32 s49, s46, 5
    s_and_b32 s49, s49, 0xe0
    v_xor_b32 v3, s49, v2
    buffer_load_dwordx4 v3, s[32:35], s48 offen nt lds
    s_waitcnt vmcnt(4)
    s_add_u32 s46, s45, 22
    s_and_b32 s46, s46, 31
    s_lshl_b32 s47, s46, 10
    s_add_u32 s48, s47, s59
    s_add_u32 m0, s47, s58
    s_lshl_b32 s49, s46, 5
    s_and_b32 s49, s49, 0xe0
    v_xor_b32 v3, s49, v2
    buffer_load_dwordx4 v3, s[32:35], s48 offen nt lds
    s_waitcnt vmcnt(4)
    s_add_u32 s46, s45, 23
    s_and_b32 s46, s46, 31
    s_lshl_b32 s47, s46, 10
    s_add_u32 s48, s47, s59
    s_add_u32 m0, s47, s58
    s_lshl_b32 s49, s46, 5
    s_and_b32 s49, s49, 0xe0
    v_xor_b32 v3, s49, v2
    buffer_load_dwordx4 v3, s[32:35], s48 offen nt lds
    s_waitcnt vmcnt(4)
    s_add_u32 s46, s45, 24
    s_and_b32 s46, s46, 31
    s_lshl_b32 s47, s46, 10
    s_add_u32 s48, s47, s59
    s_add_u32 m0, s47, s58
    s_lshl_b32 s49, s46, 5
    s_and_b32 s49, s49, 0xe0
    v_xor_b32 v3, s49, v2
    buffer_load_dwordx4 v3, s[32:35], s48 offen nt lds
    s_waitcnt vmcnt(4)
    s_add_u32 s46, s45, 25
    s_and_b32 s46, s46, 31
    s_lshl_b32 s47, s46, 10
    s_add_u32 s48, s47, s59
    s_add_u32 m0, s47, s58
    s_lshl_b32 s49, s46, 5
    s_and_b32 s49, s49, 0xe0
    v_xor_b32 v3, s49, v2
    buffer_load_dwordx4 v3, s[32:35], s48 offen nt lds
    s_waitcnt vmcnt(4)
    s_add_u32 s46, s45, 26
    s_and_b32 s46, s46, 31
    s_lshl_b32 s47, s46, 10
    s_add_u32 s48, s47, s59
    s_add_u32 m0, s47, s58
    s_lshl_b32 s49, s46, 5
    s_and_b32 s49, s49, 0xe0
    v_xor_b32 v3, s49, v2
    buffer_load_dwordx4 v3, s[32:35], s48 offen nt lds
    s_waitcnt vmcnt(4)
    s_add_u32 s46, s45, 27
    s_and_b32 s46, s46, 31
    s_lshl_b32 s47, s46, 10
    s_add_u32 s48, s47, s59
    s_add_u32 m0, s47, s58
    s_lshl_b32 s49, s46, 5
    s_and_b32 s49, s49, 0xe0
    v_xor_b32 v3, s49, v2
    buffer_load_dwordx4 v3, s[32:35], s48 offen nt lds
    s_waitcnt vmcnt(4)
    s_add_u32 s46, s45, 28
    s_and_b32 s46, s46, 31
    s_lshl_b32 s47, s46, 10
    s_add_u32 s48, s47, s59
    s_add_u32 m0, s47, s58
    s_lshl_b32 s49, s46, 5
    s_and_b32 s49, s49, 0xe0
    v_xor_b32 v3, s49, v2
    buffer_load_dwordx4 v3, s[32:35], s48 offen nt lds
    s_waitcnt vmcnt(4)
    s_add_u32 s46, s45, 29
    s_and_b32 s46, s46, 31
    s_lshl_b32 s47, s46, 10
    s_add_u32 s48, s47, s59
    s_add_u32 m0, s47, s58
    s_lshl_b32 s49, s46, 5
    s_and_b32 s49, s49, 0xe0
    v_xor_b32 v3, s49, v2
    buffer_load_dwordx4 v3, s[32:35], s48 offen nt lds
    s_waitcnt vmcnt(4)
    s_add_u32 s46, s45, 30
    s_and_b32 s46, s46, 31
    s_lshl_b32 s47, s46, 10
    s_add_u32 s48, s47, s59
    s_add_u32 m0, s47, s58
    s_lshl_b32 s49, s46, 5
    s_and_b32 s49, s49, 0xe0
    v_xor_b32 v3, s49, v2
    buffer_load_dwordx4 v3, s[32:35], s48 offen nt lds
    s_waitcnt vmcnt(4)
    s_add_u32 s46, s45, 31
    s_and_b32 s46, s46, 31
    s_lshl_b32 s47, s46, 10
    s_add_u32 s48, s47, s59
    s_add_u32 m0, s47, s58
    s_lshl_b32 s49, s46, 5
    s_and_b32 s49, s49, 0xe0
    v_xor_b32 v3, s49, v2
    buffer_load_dwordx4 v3, s[32:35], s48 offen nt lds
    s_waitcnt vmcnt(4)
    s_add_u32 s48, s44, 0
    buffer_load_dwordx4 v[64:67], v4, s[36:39], s48 offen offset:0 nt
    s_waitcnt vmcnt(4)
    buffer_load_dwordx4 v[68:71], v4, s[36:39], s48 offen offset:512 nt
    s_waitcnt vmcnt(4)
    buffer_load_dwordx4 v[72:75], v4, s[36:39], s48 offen offset:1024 nt
    s_waitcnt vmcnt(4)
    buffer_load_dwordx4 v[76:79], v4, s[36:39], s48 offen offset:1536 nt
    s_waitcnt vmcnt(4)
    v_mov_b32 v9, 2
    ds_write_b32 v11, v9 offset:2560
    buffer_load_dwordx4 v[80:83], v4, s[36:39], s48 offen offset:2048 nt
    s_waitcnt vmcnt(4)
    buffer_load_dwordx4 v[84:87], v4, s[36:39], s48 offen offset:2560 nt
    s_waitcnt vmcnt(4)
    v_perm_b32 v192, v68, v64, s52
    v_perm_b32 v196, v68, v64, s53
    v_perm_b32 v200, v69, v65, s52
    v_perm_b32 v204, v69, v65, s53
    v_perm_b32 v208, v70, v66, s52
    v_perm_b32 v212, v70, v66, s53
    v_perm_b32 v216, v71, v67, s52
    v_perm_b32 v220, v71, v67, s53
    buffer_load_dwordx4 v[88:91], v4, s[36:39], s48 offen offset:3072 nt
    s_waitcnt vmcnt(4)
    buffer_load_dwordx4 v[92:95], v4, s[36:39], s48 offen offset:3584 nt
    s_waitcnt vmcnt(4)
    v_perm_b32 v193, v76, v72, s52
    v_perm_b32 v197, v76, v72, s53
    v_perm_b32 v201, v77, v73, s52
    v_perm_b32 v205, v77, v73, s53
    v_perm_b32 v209, v78, v74, s52
    v_perm_b32 v213, v78, v74, s53
    v_perm_b32 v217, v79, v75, s52
    v_perm_b32 v221, v79, v75, s53
    s_add_u32 s48, s44, 32768
    buffer_load_dwordx4 v[96:99], v4, s[36:39], s48 offen offset:0 nt
    s_waitcnt vmcnt(4)
    buffer_load_dwordx4 v[100:103], v4, s[36:39], s48 offen offset:512 nt
    s_waitcnt vmcnt(4)
    v_perm_b32 v194, v84, v80, s52
    v_perm_b32 v198, v84, v80, s53
    v_perm_b32 v202, v85, v81, s52
    v_perm_b32 v206, v85, v81, s53
    v_perm_b32 v210, v86, v82, s52
    v_perm_b32 v214, v86, v82, s53
    v_perm_b32 v218, v87, v83, s52
    v_perm_b32 v222, v87, v83, s53
    buffer_load_dwordx4 v[104:107], v4, s[36:39], s48 offen offset:1024 nt
    s_waitcnt vmcnt(4)
    buffer_load_dwordx4 v[108:111], v4, s[36:39], s48 offen offset:1536 nt
    s_waitcnt vmcnt(4)
    v_perm_b32 v195, v92, v88, s52
    v_perm_b32 v199, v92, v88, s53
    v_perm_b32 v203, v93, v89, s52
    v_perm_b32 v207, v93, v89, s53
    v_perm_b32 v211, v94, v90, s52
    v_perm_b32 v215, v94, v90, s53
    v_perm_b32 v219, v95, v91, s52
    v_perm_b32 v223, v95, v91, s53
    buffer_load_dwordx4 v[112:115], v4, s[36:39], s48 offen offset:2048 nt
    s_waitcnt vmcnt(4)
    buffer_load_dwordx4 v[116:119], v4, s[36:39], s48 offen offset:2560 nt
    s_waitcnt vmcnt(4)
    v_perm_b32 v64, v100, v96, s52
    v_perm_b32 v68, v100, v96, s53
    v_perm_b32 v72, v101, v97, s52
    v_perm_b32 v76, v101, v97, s53
    v_perm_b32 v80, v102, v98, s52
    v_perm_b32 v84, v102, v98, s53
    v_perm_b32 v88, v103, v99, s52
    v_perm_b32 v92, v103, v99, s53
    buffer_load_dwordx4 v[120:123], v4, s[36:39], s48 offen offset:3072 nt
    s_waitcnt vmcnt(4)
    buffer_load_dwordx4 v[124:127], v4, s[36:39], s48 offen offset:3584 nt
    s_waitcnt vmcnt(4)
    v_perm_b32 v65, v108, v104, s52
    v_perm_b32 v69, v108, v104, s53
    v_perm_b32 v73, v109, v105, s52
    v_perm_b32 v77, v109, v105, s53
    v_perm_b32 v81, v110, v106, s52
    v_perm_b32 v85, v110, v106, s53
    v_perm_b32 v89, v111, v107, s52
    v_perm_b32 v93, v111, v107, s53
    s_add_u32 s48, s44, 65536
    buffer_load_dwordx4 v[128:131], v4, s[36:39], s48 offen offset:0 nt
    s_waitcnt vmcnt(4)
    buffer_load_dwordx4 v[132:135], v4, s[36:39], s48 offen offset:512 nt
    s_waitcnt vmcnt(4)
    v_perm_b32 v66, v116, v112, s52
    v_perm_b32 v70, v116, v112, s53
    v_perm_b32 v74, v117, v113, s52
    v_perm_b32 v78, v117, v113, s53
    v_perm_b32 v82, v118, v114, s52
    v_perm_b32 v86, v118, v114, s53
    v_perm_b32 v90, v119, v115, s52
    v_perm_b32 v94, v119, v115, s53
    v_mov_b32 v9, 3
    ds_write_b32 v11, v9 offset:2560
    buffer_load_dwordx4 v[136:139], v4, s[36:39], s48 offen offset:1024 nt
    s_waitcnt vmcnt(4)
    buffer_load_dwordx4 v[140:143], v4, s[36:39], s48 offen offset:1536 nt
    s_waitcnt vmcnt(4)
    v_perm_b32 v67, v124, v120, s52
    v_perm_b32 v71, v124, v120, s53
    v_perm_b32 v75, v125, v121, s52
    v_perm_b32 v79, v125, v121, s53
    v_perm_b32 v83, v126, v122, s52
    v_perm_b32 v87, v126, v122, s53
    v_perm_b32 v91, v127, v123, s52
    v_perm_b32 v95, v127, v123, s53
    buffer_load_dwordx4 v[144:147], v4, s[36:39], s48 offen offset:2048 nt
    s_waitcnt vmcnt(4)
    buffer_load_dwordx4 v[148:151], v4, s[36:39], s48 offen offset:2560 nt
    s_waitcnt vmcnt(4)
    v_perm_b32 v96, v132, v128, s52
    v_perm_b32 v100, v132, v128, s53
    v_perm_b32 v104, v133, v129, s52
    v_perm_b32 v108, v133, v129, s53
    v_perm_b32 v112, v134, v130, s52
    v_perm_b32 v116, v134, v130, s53
    v_perm_b32 v120, v135, v131, s52
    v_perm_b32 v124, v135, v131, s53
    buffer_load_dwordx4 v[152:155], v4, s[36:39], s48 offen offset:3072 nt
    s_waitcnt vmcnt(4)
    buffer_load_dwordx4 v[156:159], v4, s[36:39], s48 offen offset:3584 nt
    s_waitcnt vmcnt(4)
    v_perm_b32 v97, v140, v136, s52
    v_perm_b32 v101, v140, v136, s53
    v_perm_b32 v105, v141, v137, s52
    v_perm_b32 v109, v141, v137, s53
    v_perm_b32 v113, v142, v138, s52
    v_perm_b32 v117, v142, v138, s53
    v_perm_b32 v121, v143, v139, s52
    v_perm_b32 v125, v143, v139, s53
    s_add_u32 s48, s44, 98304
    buffer_load_dwordx4 v[160:163], v4, s[36:39], s48 offen offset:0 nt
    s_waitcnt vmcnt(4)
    buffer_load_dwordx4 v[164:167], v4, s[36:39], s48 offen offset:512 nt
    s_waitcnt vmcnt(4)
    v_perm_b32 v98, v148, v144, s52
    v_perm_b32 v102, v148, v144, s53
    v_perm_b32 v106, v149, v145, s52
    v_perm_b32 v110, v149, v145, s53
    v_perm_b32 v114, v150, v146, s52
    v_perm_b32 v118, v150, v146, s53
    v_perm_b32 v122, v151, v147, s52
    v_perm_b32 v126, v151, v147, s53
    buffer_load_dwordx4 v[168:171], v4, s[36:39], s48 offen offset:1024 nt
    s_waitcnt vmcnt(4)
    buffer_load_dwordx4 v[172:175], v4, s[36:39], s48 offen offset:1536 nt
    s_waitcnt vmcnt(4)
    v_perm_b32 v99, v156, v152, s52
    v_perm_b32 v103, v156, v152, s53
    v_perm_b32 v107, v157, v153, s52
    v_perm_b32 v111, v157, v153, s53
    v_perm_b32 v115, v158, v154, s52
    v_perm_b32 v119, v158, v154, s53
    v_perm_b32 v123, v159, v155, s52
    v_perm_b32 v127, v159, v155, s53
    buffer_load_dwordx4 v[176:179], v4, s[36:39], s48 offen offset:2048 nt
    s_waitcnt vmcnt(4)
    buffer_load_dwordx4 v[180:183], v4, s[36:39], s48 offen offset:2560 nt
    s_waitcnt vmcnt(4)
    v_perm_b32 v128, v164, v160, s52
    v_perm_b32 v132, v164, v160, s53
    v_perm_b32 v136, v165, v161, s52
    v_perm_b32 v140, v165, v161, s53
    v_perm_b32 v144, v166, v162, s52
    v_perm_b32 v148, v166, v162, s53
    v_perm_b32 v152, v167, v163, s52
    v_perm_b32 v156, v167, v163, s53
    buffer_load_dwordx4 v[184:187], v4, s[36:39], s48 offen offset:3072 nt
    s_waitcnt vmcnt(4)
    buffer_load_dwordx4 v[188:191], v4, s[36:39], s48 offen offset:3584 nt
    s_waitcnt vmcnt(4)
    v_perm_b32 v129, v172, v168, s52
    v_perm_b32 v133, v172, v168, s53
    v_perm_b32 v137, v173, v169, s52
    v_perm_b32 v141, v173, v169, s53
    v_perm_b32 v145, v174, v170, s52
    v_perm_b32 v149, v174, v170, s53
    v_perm_b32 v153, v175, v171, s52
    v_perm_b32 v157, v175, v171, s53
    v_mov_b32 v9, 4
    ds_write_b32 v11, v9 offset:2560
    s_setprio 3
    s_waitcnt lgkmcnt(0)
    s_bfe_u32 s50, s50, 0x50003
    s_cmp_eq_u32 s50, 31
    s_cselect_b32 s50, 0, s50
    s_add_u32 s50, s50, 1
    s_lshl_b32 s50, s50, 3
    s_getreg_b32 s51, hwreg(HW_REG_XCC_ID)
    s_and_b32 s51, s51, 7
    s_or_b32 s51, s51, s50
    v_and_b32 v1, 15, v0
    v_lshrrev_b32 v2, 4, v0
    v_bfe_u32 v3, v1, 1, 1
    v_lshlrev_b32 v3, 9, v3
    v_lshl_add_u32 v3, v2, 5, v3
    v_and_b32 v9, 1, v1
    v_lshl_add_u32 v3, v9, 4, v3
    v_add_u32 v3, 1024, v3
    v_mov_b32 v9, 2048
    v_lshrrev_b32 v1, 2, v1
    v_cmp_eq_u32 vcc, 0, v1
    s_nop 1
    v_cndmask_b32 v5, v9, v3, vcc
    v_cmp_eq_u32 vcc, 1, v1
    s_nop 1
    v_cndmask_b32 v6, v9, v3, vcc
    v_cmp_eq_u32 vcc, 2, v1
    s_nop 1
    v_cndmask_b32 v7, v9, v3, vcc
    v_cmp_eq_u32 vcc, 3, v1
    s_nop 1
    v_cndmask_b32 v8, v9, v3, vcc
    v_bfe_u32 v1, v0, 3, 1
    v_lshlrev_b32 v1, 15, v1
    v_and_b32 v3, 7, v0
    v_lshl_add_u32 v1, v3, 3, v1
    v_lshl_add_u32 v1, v2, 6, v1
    s_lshl_b32 s46, s28, 2
    s_lshr_b32 s47, s3, 1
    s_add_u32 s46, s46, s47
    s_lshl_b32 s46, s46, 14
    s_lshl_b32 s47, s29, 11
    s_add_u32 s46, s46, s47
    s_lshl_b32 s47, s30, 9
    s_add_u32 s46, s46, s47
    s_and_b32 s47, s3, 1
    s_lshl_b32 s47, s47, 8
    s_add_u32 s46, s46, s47
    s_add_u32 s60, s46, 1052672
    v_mov_b32 v36, 0xffffff00
LW_1:
    ds_read_b128 v[40:43], v10 offset:2576
    s_waitcnt lgkmcnt(0)
    v_min_u32 v40, v40, v41
    v_min3_u32 v40, v40, v42, v43
    s_nop 0
    v_readfirstlane_b32 s46, v40
    s_nop 0
    s_cmp_ge_u32 s46, 3
    s_cbranch_scc1 LWD_2
    s_sleep 1
    s_branch LW_1
LWD_2:
    ds_read_b128 v[40:43], v10 offset:2592
    s_waitcnt lgkmcnt(0)
    v_or_b32 v40, v40, v41
    v_or3_b32 v40, v40, v42, v43
    s_nop 0
    v_readfirstlane_b32 s63, v40
    s_nop 0
    s_nop 1
    ds_read_b128 v[20:23], v5 offset:0
    ds_read_b128 v[24:27], v6 offset:0
    ds_read_b128 v[28:31], v7 offset:0
    ds_read_b128 v[32:35], v8 offset:0
    s_waitcnt lgkmcnt(3)
    v_mfma_f32_16x16x32_bf16 v[12:15], v[20:23], v[192:195], 0
    s_waitcnt lgkmcnt(2)
    v_mfma_f32_16x16x32_bf16 v[12:15], v[24:27], v[196:199], v[12:15]
    s_waitcnt lgkmcnt(1)
    v_mfma_f32_16x16x32_bf16 v[12:15], v[28:31], v[200:203], v[12:15]
    s_waitcnt lgkmcnt(0)
    v_mfma_f32_16x16x32_bf16 v[12:15], v[32:35], v[204:207], v[12:15]
    v_mfma_f32_16x16x32_bf16 v[16:19], v[20:23], v[208:211], 0
    v_mfma_f32_16x16x32_bf16 v[16:19], v[24:27], v[212:215], v[16:19]
    v_mfma_f32_16x16x32_bf16 v[16:19], v[28:31], v[216:219], v[16:19]
    v_mfma_f32_16x16x32_bf16 v[16:19], v[32:35], v[220:223], v[16:19]
    s_nop 1
    ds_read_b128 v[20:23], v5 offset:128
    ds_read_b128 v[24:27], v6 offset:128
    ds_read_b128 v[28:31], v7 offset:128
    ds_read_b128 v[32:35], v8 offset:128
    s_waitcnt lgkmcnt(3)
    v_mfma_f32_16x16x32_bf16 v[12:15], v[20:23], v[64:67], v[12:15]
    s_waitcnt lgkmcnt(2)
    v_mfma_f32_16x16x32_bf16 v[12:15], v[24:27], v[68:71], v[12:15]
    s_waitcnt lgkmcnt(1)
    v_mfma_f32_16x16x32_bf16 v[12:15], v[28:31], v[72:75], v[12:15]
    s_waitcnt lgkmcnt(0)
    v_mfma_f32_16x16x32_bf16 v[12:15], v[32:35], v[76:79], v[12:15]
    v_mfma_f32_16x16x32_bf16 v[16:19], v[20:23], v[80:83], v[16:19]
    v_mfma_f32_16x16x32_bf16 v[16:19], v[24:27], v[84:87], v[16:19]
    v_mfma_f32_16x16x32_bf16 v[16:19], v[28:31], v[88:91], v[16:19]
    v_mfma_f32_16x16x32_bf16 v[16:19], v[32:35], v[92:95], v[16:19]
    s_nop 1
    ds_read_b128 v[20:23], v5 offset:256
    ds_read_b128 v[24:27], v6 offset:256
    ds_read_b128 v[28:31], v7 offset:256
    ds_read_b128 v[32:35], v8 offset:256
    s_waitcnt lgkmcnt(3)
    v_mfma_f32_16x16x32_bf16 v[12:15], v[20:23], v[96:99], v[12:15]
    s_waitcnt lgkmcnt(2)
    v_mfma_f32_16x16x32_bf16 v[12:15], v[24:27], v[100:103], v[12:15]
    s_waitcnt lgkmcnt(1)
    v_mfma_f32_16x16x32_bf16 v[12:15], v[28:31], v[104:107], v[12:15]
    s_waitcnt lgkmcnt(0)
    v_mfma_f32_16x16x32_bf16 v[12:15], v[32:35], v[108:111], v[12:15]
    v_mfma_f32_16x16x32_bf16 v[16:19], v[20:23], v[112:115], v[16:19]
    v_mfma_f32_16x16x32_bf16 v[16:19], v[24:27], v[116:119], v[16:19]
    v_mfma_f32_16x16x32_bf16 v[16:19], v[28:31], v[120:123], v[16:19]
    v_mfma_f32_16x16x32_bf16 v[16:19], v[32:35], v[124:127], v[16:19]
    ds_read_b128 v[20:23], v5 offset:384
    ds_read_b128 v[24:27], v6 offset:384
    ds_read_b128 v[28:31], v7 offset:384
    ds_read_b128 v[32:35], v8 offset:384
    s_waitcnt vmcnt(3)
    s_waitcnt vmcnt(2)
    v_perm_b32 v130, v180, v176, s52
    v_perm_b32 v134, v180, v176, s53
    v_perm_b32 v138, v181, v177, s52
    v_perm_b32 v142, v181, v177, s53
    v_perm_b32 v146, v182, v178, s52
    v_perm_b32 v150, v182, v178, s53
    v_perm_b32 v154, v183, v179, s52
    v_perm_b32 v158, v183, v179, s53
    s_waitcnt vmcnt(1)
    s_waitcnt vmcnt(0)
    v_perm_b32 v131, v188, v184, s52
    v_perm_b32 v135, v188, v184, s53
    v_perm_b32 v139, v189, v185, s52
    v_perm_b32 v143, v189, v185, s53
    v_perm_b32 v147, v190, v186, s52
    v_perm_b32 v151, v190, v186, s53
    v_perm_b32 v155, v191, v187, s52
    v_perm_b32 v159, v191, v187, s53
    s_waitcnt lgkmcnt(0)
    s_nop 0
    v_mfma_f32_16x16x32_bf16 v[12:15], v[20:23], v[128:131], v[12:15]
    v_mfma_f32_16x16x32_bf16 v[12:15], v[24:27], v[132:135], v[12:15]
    v_mfma_f32_16x16x32_bf16 v[12:15], v[28:31], v[136:139], v[12:15]
    v_mfma_f32_16x16x32_bf16 v[12:15], v[32:35], v[140:143], v[12:15]
    v_mfma_f32_16x16x32_bf16 v[16:19], v[20:23], v[144:147], v[16:19]
    v_mfma_f32_16x16x32_bf16 v[16:19], v[24:27], v[148:151], v[16:19]
    v_mfma_f32_16x16x32_bf16 v[16:19], v[28:31], v[152:155], v[16:19]
    v_mfma_f32_16x16x32_bf16 v[16:19], v[32:35], v[156:159], v[16:19]
    s_nop 3
    v_cndmask_b32 v42, v14, v13, s[56:57]
    v_cndmask_b32 v40, v12, v15, s[56:57]
    s_nop 1
    v_cndmask_b32 v43, v18, v17, s[56:57]
    v_cndmask_b32 v41, v16, v19, s[56:57]
    v_add_f32_dpp v40, v42, v40 row_ror:8 row_mask:0xf bank_mask:0xf
    s_nop 0
    v_add_f32_dpp v41, v43, v41 row_ror:8 row_mask:0xf bank_mask:0xf
    v_and_or_b32 v40, v40, v36, s50
    v_and_or_b32 v41, v41, v36, s50
    s_cmp_lg_u32 s63, 0
    s_cbranch_scc1 SL_3
    buffer_store_dwordx2 v[40:41], v1, s[40:43], s60 offen
    s_branch SD_4
SL_3:
    buffer_store_dwordx2 v[40:41], v1, s[40:43], s60 offen sc1
SD_4:
    v_mov_b32 v9, 5
    ds_write_b32 v11, v9 offset:2560
    s_endpgm
L_X:
    s_setprio 3
    s_sub_u32 s61, s3, 4
    s_mov_b32 s62, 1
    s_mov_b32 s63, 0
    s_mov_b32 s55, 0
    v_and_b32 v1, 7, v0
    v_lshrrev_b32 v2, 3, v0
    v_and_b32 v5, 15, v0
    v_lshrrev_b32 v6, 4, v0
    v_and_b32 v7, 1, v5
    v_lshl_add_u32 v7, v6, 1, v7
    v_lshrrev_b32 v16, 1, v5
    v_mov_b32 v17, 0
    v_mov_b32 v18, 0xffffff00
    v_mov_b32 v19, 1073741824
    v_mov_b32 v35, 1073741824
    v_mul_u32_u24 v4, 896, v16
    v_lshl_add_u32 v4, v7, 4, v4
    v_cmp_eq_u32 vcc, 7, v7
    s_nop 1
    v_cndmask_b32 v4, v4, v19, vcc
    v_cmp_eq_u32 s[64:65], 7, v2
    s_waitcnt lgkmcnt(0)
    s_mov_b32 s40, s26
    s_mov_b32 s41, s27
    s_mov_b32 s42, 536870912
    s_mov_b32 s43, 0x20000
    s_mov_b32 s32, s4
    s_mov_b32 s33, s5
    s_mov_b32 s34, 7168
    s_mov_b32 s35, 0x20000
    s_load_dword s50, s[26:27], 0
    s_cmp_eq_u32 s3, 5
    s_cbranch_scc1 L_X5
    s_cmp_eq_u32 s3, 6
    s_cbranch_scc1 L_X6
    s_cmp_eq_u32 s3, 7
    s_cbranch_scc1 L_X7
    s_mov_b32 s36, s10
    s_mov_b32 s37, s11
    s_mov_b32 s38, 3670016
    s_mov_b32 s39, 0x20000
    v_lshlrev_b32 v3, 16, v2
    v_lshl_add_u32 v3, v1, 4, v3
    v_mov_b32 v35, v3
    v_cndmask_b32 v3, v3, v19, s[64:65]
    s_mul_i32 s46, s30, 917504
    s_lshl_b32 s47, s28, 3
    s_add_u32 s47, s47, s29
    s_lshl_b32 s47, s47, 7
    s_add_u32 s46, s46, s47
    s_mul_i32 s47, s30, 224
    s_add_u32 s48, s46, 0
    buffer_load_dwordx4 v[64:67], v3, s[36:39], s48 offen nt
    s_add_u32 s48, s46, 8192
    buffer_load_dwordx4 v[68:71], v3, s[36:39], s48 offen nt
    s_add_u32 s48, s46, 16384
    buffer_load_dwordx4 v[72:75], v3, s[36:39], s48 offen nt
    s_add_u32 s48, s46, 24576
    buffer_load_dwordx4 v[76:79], v3, s[36:39], s48 offen nt
    s_add_u32 s48, s46, 32768
    buffer_load_dwordx4 v[80:83], v3, s[36:39], s48 offen nt
    s_add_u32 s48, s46, 40960
    buffer_load_dwordx4 v[84:87], v3, s[36:39], s48 offen nt
    s_add_u32 s48, s46, 49152
    buffer_load_dwordx4 v[88:91], v3, s[36:39], s48 offen nt
    s_add_u32 s48, s46, 57344
    buffer_load_dwordx4 v[92:95], v3, s[36:39], s48 offen nt
    buffer_load_dwordx4 v[8:11], v4, s[32:35], s47 offen offset:0
    s_add_u32 s48, s46, 458752
    buffer_load_dwordx4 v[96:99], v3, s[36:39], s48 offen nt
    s_add_u32 s48, s46, 466944
    buffer_load_dwordx4 v[100:103], v3, s[36:39], s48 offen nt
    s_add_u32 s48, s46, 475136
    buffer_load_dwordx4 v[104:107], v3, s[36:39], s48 offen nt
    s_add_u32 s48, s46, 483328
    buffer_load_dwordx4 v[108:111], v3, s[36:39], s48 offen nt
    s_add_u32 s48, s46, 491520
    buffer_load_dwordx4 v[112:115], v3, s[36:39], s48 offen nt
    s_add_u32 s48, s46, 499712
    buffer_load_dwordx4 v[116:119], v3, s[36:39], s48 offen nt
    s_add_u32 s48, s46, 507904
    buffer_load_dwordx4 v[120:123], v3, s[36:39], s48 offen nt
    s_add_u32 s48, s46, 516096
    buffer_load_dwordx4 v[124:127], v3, s[36:39], s48 offen nt
    buffer_load_dwordx4 v[12:15], v4, s[32:35], s47 offen offset:112
    s_barrier
    s_lshl_b32 s46, s28, 1
    s_lshr_b32 s47, s29, 2
    s_add_u32 s46, s46, s47
    s_lshl_b32 s46, s46, 12
    s_lshl_b32 s47, s30, 10
    s_add_u32 s46, s46, s47
    s_and_b32 s47, s29, 3
    s_lshl_b32 s47, s47, 8
    s_add_u32 s46, s46, s47
    s_add_u32 s55, s46, 4096
    s_waitcnt vmcnt(9)
    v_perm_b32 v160, v68, v64, s52
    v_perm_b32 v164, v68, v64, s53
    v_perm_b32 v168, v69, v65, s52
    v_perm_b32 v172, v69, v65, s53
    v_perm_b32 v176, v70, v66, s52
    v_perm_b32 v180, v70, v66, s53
    v_perm_b32 v184, v71, v67, s52
    v_perm_b32 v188, v71, v67, s53
    v_perm_b32 v161, v76, v72, s52
    v_perm_b32 v165, v76, v72, s53
    v_perm_b32 v169, v77, v73, s52
    v_perm_b32 v173, v77, v73, s53
    v_perm_b32 v177, v78, v74, s52
    v_perm_b32 v181, v78, v74, s53
    v_perm_b32 v185, v79, v75, s52
    v_perm_b32 v189, v79, v75, s53
    v_perm_b32 v162, v84, v80, s52
    v_perm_b32 v166, v84, v80, s53
    v_perm_b32 v170, v85, v81, s52
    v_perm_b32 v174, v85, v81, s53
    v_perm_b32 v178, v86, v82, s52
    v_perm_b32 v182, v86, v82, s53
    v_perm_b32 v186, v87, v83, s52
    v_perm_b32 v190, v87, v83, s53
    v_perm_b32 v163, v92, v88, s52
    v_perm_b32 v167, v92, v88, s53
    v_perm_b32 v171, v93, v89, s52
    v_perm_b32 v175, v93, v89, s53
    v_perm_b32 v179, v94, v90, s52
    v_perm_b32 v183, v94, v90, s53
    v_perm_b32 v187, v95, v91, s52
    v_perm_b32 v191, v95, v91, s53
    s_nop 1
    v_mfma_f32_16x16x32_bf16 v[224:227], v[8:11], v[160:163], 0
    v_mfma_f32_16x16x32_bf16 v[228:231], v[8:11], v[164:167], 0
    v_mfma_f32_16x16x32_bf16 v[232:235], v[8:11], v[168:171], 0
    v_mfma_f32_16x16x32_bf16 v[236:239], v[8:11], v[172:175], 0
    v_mfma_f32_16x16x32_bf16 v[240:243], v[8:11], v[176:179], 0
    v_mfma_f32_16x16x32_bf16 v[244:247], v[8:11], v[180:183], 0
    v_mfma_f32_16x16x32_bf16 v[248:251], v[8:11], v[184:187], 0
    v_mfma_f32_16x16x32_bf16 v[252:255], v[8:11], v[188:191], 0
    s_waitcnt vmcnt(0)
    v_perm_b32 v192, v100, v96, s52
    v_perm_b32 v196, v100, v96, s53
    v_perm_b32 v200, v101, v97, s52
    v_perm_b32 v204, v101, v97, s53
    v_perm_b32 v208, v102, v98, s52
    v_perm_b32 v212, v102, v98, s53
    v_perm_b32 v216, v103, v99, s52
    v_perm_b32 v220, v103, v99, s53
    v_perm_b32 v193, v108, v104, s52
    v_perm_b32 v197, v108, v104, s53
    v_perm_b32 v201, v109, v105, s52
    v_perm_b32 v205, v109, v105, s53
    v_perm_b32 v209, v110, v106, s52
    v_perm_b32 v213, v110, v106, s53
    v_perm_b32 v217, v111, v107, s52
    v_perm_b32 v221, v111, v107, s53
    v_perm_b32 v194, v116, v112, s52
    v_perm_b32 v198, v116, v112, s53
    v_perm_b32 v202, v117, v113, s52
    v_perm_b32 v206, v117, v113, s53
    v_perm_b32 v210, v118, v114, s52
    v_perm_b32 v214, v118, v114, s53
    v_perm_b32 v218, v119, v115, s52
    v_perm_b32 v222, v119, v115, s53
    v_perm_b32 v195, v124, v120, s52
    v_perm_b32 v199, v124, v120, s53
    v_perm_b32 v203, v125, v121, s52
    v_perm_b32 v207, v125, v121, s53
    v_perm_b32 v211, v126, v122, s52
    v_perm_b32 v215, v126, v122, s53
    v_perm_b32 v219, v127, v123, s52
    v_perm_b32 v223, v127, v123, s53
    s_nop 1
    v_mfma_f32_16x16x32_bf16 v[224:227], v[12:15], v[192:195], v[224:227]
    v_mfma_f32_16x16x32_bf16 v[228:231], v[12:15], v[196:199], v[228:231]
    v_mfma_f32_16x16x32_bf16 v[232:235], v[12:15], v[200:203], v[232:235]
    v_mfma_f32_16x16x32_bf16 v[236:239], v[12:15], v[204:207], v[236:239]
    v_mfma_f32_16x16x32_bf16 v[240:243], v[12:15], v[208:211], v[240:243]
    v_mfma_f32_16x16x32_bf16 v[244:247], v[12:15], v[212:215], v[244:247]
    v_mfma_f32_16x16x32_bf16 v[248:251], v[12:15], v[216:219], v[248:251]
    v_mfma_f32_16x16x32_bf16 v[252:255], v[12:15], v[220:223], v[252:255]
    s_waitcnt lgkmcnt(0)
    s_bfe_u32 s50, s50, 0x50003
    s_cmp_eq_u32 s50, 31
    s_cselect_b32 s50, 0, s50
    s_add_u32 s50, s50, 1
    s_lshl_b32 s50, s50, 3
    s_getreg_b32 s51, hwreg(HW_REG_XCC_ID)
    s_and_b32 s51, s51, 7
    s_or_b32 s51, s51, s50
    v_cndmask_b32 v36, v226, v225, s[56:57]
    v_cndmask_b32 v20, v224, v227, s[56:57]
    v_cndmask_b32 v37, v230, v229, s[56:57]
    v_cndmask_b32 v21, v228, v231, s[56:57]
    v_cndmask_b32 v38, v234, v233, s[56:57]
    v_cndmask_b32 v22, v232, v235, s[56:57]
    v_cndmask_b32 v39, v238, v237, s[56:57]
    v_cndmask_b32 v23, v236, v239, s[56:57]
    v_cndmask_b32 v40, v242, v241, s[56:57]
    v_cndmask_b32 v24, v240, v243, s[56:57]
    v_cndmask_b32 v41, v246, v245, s[56:57]
    v_cndmask_b32 v25, v244, v247, s[56:57]
    v_cndmask_b32 v42, v250, v249, s[56:57]
    v_cndmask_b32 v26, v248, v251, s[56:57]
    v_cndmask_b32 v43, v254, v253, s[56:57]
    v_cndmask_b32 v27, v252, v255, s[56:57]
    v_add_f32_dpp v20, v36, v20 row_ror:8 row_mask:0xf bank_mask:0xf
    v_add_f32_dpp v21, v37, v21 row_ror:8 row_mask:0xf bank_mask:0xf
    v_add_f32_dpp v22, v38, v22 row_ror:8 row_mask:0xf bank_mask:0xf
    v_add_f32_dpp v23, v39, v23 row_ror:8 row_mask:0xf bank_mask:0xf
    v_add_f32_dpp v24, v40, v24 row_ror:8 row_mask:0xf bank_mask:0xf
    v_add_f32_dpp v25, v41, v25 row_ror:8 row_mask:0xf bank_mask:0xf
    v_add_f32_dpp v26, v42, v26 row_ror:8 row_mask:0xf bank_mask:0xf
    v_add_f32_dpp v27, v43, v27 row_ror:8 row_mask:0xf bank_mask:0xf
    v_add_u32 v20, 0x80, v20
    v_add_u32 v21, 0x80, v21
    v_add_u32 v22, 0x80, v22
    v_add_u32 v23, 0x80, v23
    v_add_u32 v24, 0x80, v24
    v_add_u32 v25, 0x80, v25
    v_add_u32 v26, 0x80, v26
    v_add_u32 v27, 0x80, v27
    v_and_or_b32 v20, v20, v18, s51
    v_and_or_b32 v21, v21, v18, s51
    v_and_or_b32 v22, v22, v18, s51
    v_and_or_b32 v23, v23, v18, s51
    v_and_or_b32 v24, v24, v18, s51
    v_and_or_b32 v25, v25, v18, s51
    v_and_or_b32 v26, v26, v18, s51
    v_and_or_b32 v27, v27, v18, s51
    buffer_store_dwordx4 v[20:23], v35, s[40:43], s55 offen
    buffer_store_dwordx4 v[24:27], v35, s[40:43], s55 offen offset:128
    s_mov_b32 s62, 0
    s_branch L_XMID
L_X5:
    s_mov_b32 s36, s16
    s_mov_b32 s37, s17
    s_mov_b32 s38, 1605632
    s_mov_b32 s39, 0x20000
    v_mul_u32_u24 v3, 28672, v2
    v_lshl_add_u32 v3, v1, 4, v3
    v_mul_u32_u24 v4, 896, v16
    v_lshl_add_u32 v4, v7, 4, v4
    s_cmp_gt_u32 s29, 3
    s_cselect_b32 s45, 1, 0
    s_sub_u32 s45, s29, s45
    s_mul_i32 s46, s45, 229376
    s_lshl_b32 s47, s31, 7
    s_add_u32 s46, s46, s47
    s_lshl_b32 s47, s45, 7
    s_cmp_ge_u32 s31, 28
    s_cbranch_scc1 L_X5S
    s_cmp_eq_u32 s29, 3
    s_cbranch_scc1 L_X5S
    s_add_u32 s48, s46, 0
    buffer_load_dwordx4 v[64:67], v3, s[36:39], s48 offen nt
    s_add_u32 s48, s46, 3584
    buffer_load_dwordx4 v[68:71], v3, s[36:39], s48 offen nt
    s_add_u32 s48, s46, 7168
    buffer_load_dwordx4 v[72:75], v3, s[36:39], s48 offen nt
    s_add_u32 s48, s46, 10752
    buffer_load_dwordx4 v[76:79], v3, s[36:39], s48 offen nt
    s_add_u32 s48, s46, 14336
    buffer_load_dwordx4 v[80:83], v3, s[36:39], s48 offen nt
    s_add_u32 s48, s46, 17920
    buffer_load_dwordx4 v[84:87], v3, s[36:39], s48 offen nt
    s_add_u32 s48, s46, 21504
    buffer_load_dwordx4 v[88:91], v3, s[36:39], s48 offen nt
    s_add_u32 s48, s46, 25088
    buffer_load_dwordx4 v[92:95], v3, s[36:39], s48 offen nt
    buffer_load_dwordx4 v[8:11], v4, s[32:35], s47 offen
    s_barrier
    v_lshlrev_b32 v35, 11, v2
    v_lshl_add_u32 v35, v1, 4, v35
    s_lshl_b32 s46, s31, 14
    s_lshl_b32 s47, s45, 8
    s_add_u32 s46, s46, s47
    s_add_u32 s55, s46, 528384
    s_waitcnt vmcnt(0)
    v_perm_b32 v160, v68, v64, s52
    v_perm_b32 v164, v68, v64, s53
    v_perm_b32 v168, v69, v65, s52
    v_perm_b32 v172, v69, v65, s53
    v_perm_b32 v176, v70, v66, s52
    v_perm_b32 v180, v70, v66, s53
    v_perm_b32 v184, v71, v67, s52
    v_perm_b32 v188, v71, v67, s53
    v_perm_b32 v161, v76, v72, s52
    v_perm_b32 v165, v76, v72, s53
    v_perm_b32 v169, v77, v73, s52
    v_perm_b32 v173, v77, v73, s53
    v_perm_b32 v177, v78, v74, s52
    v_perm_b32 v181, v78, v74, s53
    v_perm_b32 v185, v79, v75, s52
    v_perm_b32 v189, v79, v75, s53
    v_perm_b32 v162, v84, v80, s52
    v_perm_b32 v166, v84, v80, s53
    v_perm_b32 v170, v85, v81, s52
    v_perm_b32 v174, v85, v81, s53
    v_perm_b32 v178, v86, v82, s52
    v_perm_b32 v182, v86, v82, s53
    v_perm_b32 v186, v87, v83, s52
    v_perm_b32 v190, v87, v83, s53
    v_perm_b32 v163, v92, v88, s52
    v_perm_b32 v167, v92, v88, s53
    v_perm_b32 v171, v93, v89, s52
    v_perm_b32 v175, v93, v89, s53
    v_perm_b32 v179, v94, v90, s52
    v_perm_b32 v183, v94, v90, s53
    v_perm_b32 v187, v95, v91, s52
    v_perm_b32 v191, v95, v91, s53
    s_nop 1
    v_mfma_f32_16x16x32_bf16 v[224:227], v[8:11], v[160:163], 0
    v_mfma_f32_16x16x32_bf16 v[228:231], v[8:11], v[164:167], 0
    v_mfma_f32_16x16x32_bf16 v[232:235], v[8:11], v[168:171], 0
    v_mfma_f32_16x16x32_bf16 v[236:239], v[8:11], v[172:175], 0
    v_mfma_f32_16x16x32_bf16 v[240:243], v[8:11], v[176:179], 0
    v_mfma_f32_16x16x32_bf16 v[244:247], v[8:11], v[180:183], 0
    v_mfma_f32_16x16x32_bf16 v[248:251], v[8:11], v[184:187], 0
    v_mfma_f32_16x16x32_bf16 v[252:255], v[8:11], v[188:191], 0
    s_waitcnt lgkmcnt(0)
    s_bfe_u32 s50, s50, 0x50003
    s_cmp_eq_u32 s50, 31
    s_cselect_b32 s50, 0, s50
    s_add_u32 s50, s50, 1
    s_lshl_b32 s50, s50, 3
    s_getreg_b32 s51, hwreg(HW_REG_XCC_ID)
    s_and_b32 s51, s51, 7
    s_or_b32 s51, s51, s50
    v_cndmask_b32 v36, v226, v225, s[56:57]
    v_cndmask_b32 v20, v224, v227, s[56:57]
    v_cndmask_b32 v37, v230, v229, s[56:57]
    v_cndmask_b32 v21, v228, v231, s[56:57]
    v_cndmask_b32 v38, v234, v233, s[56:57]
    v_cndmask_b32 v22, v232, v235, s[56:57]
    v_cndmask_b32 v39, v238, v237, s[56:57]
    v_cndmask_b32 v23, v236, v239, s[56:57]
    v_cndmask_b32 v40, v242, v241, s[56:57]
    v_cndmask_b32 v24, v240, v243, s[56:57]
    v_cndmask_b32 v41, v246, v245, s[56:57]
    v_cndmask_b32 v25, v244, v247, s[56:57]
    v_cndmask_b32 v42, v250, v249, s[56:57]
    v_cndmask_b32 v26, v248, v251, s[56:57]
    v_cndmask_b32 v43, v254, v253, s[56:57]
    v_cndmask_b32 v27, v252, v255, s[56:57]
    v_add_f32_dpp v20, v36, v20 row_ror:8 row_mask:0xf bank_mask:0xf
    v_add_f32_dpp v21, v37, v21 row_ror:8 row_mask:0xf bank_mask:0xf
    v_add_f32_dpp v22, v38, v22 row_ror:8 row_mask:0xf bank_mask:0xf
    v_add_f32_dpp v23, v39, v23 row_ror:8 row_mask:0xf bank_mask:0xf
    v_add_f32_dpp v24, v40, v24 row_ror:8 row_mask:0xf bank_mask:0xf
    v_add_f32_dpp v25, v41, v25 row_ror:8 row_mask:0xf bank_mask:0xf
    v_add_f32_dpp v26, v42, v26 row_ror:8 row_mask:0xf bank_mask:0xf
    v_add_f32_dpp v27, v43, v27 row_ror:8 row_mask:0xf bank_mask:0xf
    v_add_u32 v20, 0x80, v20
    v_add_u32 v21, 0x80, v21
    v_add_u32 v22, 0x80, v22
    v_add_u32 v23, 0x80, v23
    v_add_u32 v24, 0x80, v24
    v_add_u32 v25, 0x80, v25
    v_add_u32 v26, 0x80, v26
    v_add_u32 v27, 0x80, v27
    v_and_or_b32 v20, v20, v18, s50
    v_and_or_b32 v21, v21, v18, s50
    v_and_or_b32 v22, v22, v18, s50
    v_and_or_b32 v23, v23, v18, s50
    v_and_or_b32 v24, v24, v18, s50
    v_and_or_b32 v25, v25, v18, s50
    v_and_or_b32 v26, v26, v18, s50
    v_and_or_b32 v27, v27, v18, s50
    buffer_store_dwordx4 v[20:23], v35, s[40:43], s55 offen
    buffer_store_dwordx4 v[24:27], v35, s[40:43], s55 offen offset:128
    s_mov_b32 s62, 0
    s_branch L_XMID
L_X5S:
    s_barrier
    s_waitcnt lgkmcnt(0)
    s_bfe_u32 s50, s50, 0x50003
    s_cmp_eq_u32 s50, 31
    s_cselect_b32 s50, 0, s50
    s_add_u32 s50, s50, 1
    s_lshl_b32 s50, s50, 3
    s_getreg_b32 s51, hwreg(HW_REG_XCC_ID)
    s_and_b32 s51, s51, 7
    s_or_b32 s51, s51, s50
    s_branch L_XMID
L_X6:
    s_mov_b32 s36, s20
    s_mov_b32 s37, s21
    s_mov_b32 s38, 896
    s_mov_b32 s39, 0x20000
    v_lshlrev_b32 v3, 4, v0
    v_cmp_gt_u32 vcc, 56, v0
    s_nop 1
    v_cndmask_b32 v3, v19, v3, vcc
    s_mul_i32 s47, s29, 896
    buffer_load_dwordx4 v[8:11], v3, s[32:35], s47 offen
    buffer_load_dwordx4 v[12:15], v3, s[36:39], 0 offen
    s_barrier
    s_waitcnt vmcnt(0)
    v_mov_b32 v20, 0
    v_lshlrev_b32 v21, 16, v8
    v_and_b32 v22, 0xffff0000, v8
    v_lshlrev_b32 v23, 16, v12
    v_and_b32 v24, 0xffff0000, v12
    v_mul_f32 v21, v21, v23
    v_mul_f32 v22, v22, v24
    v_cvt_pk_bf16_f32 v21, v21, v22
    v_lshlrev_b32 v22, 16, v21
    v_and_b32 v21, 0xffff0000, v21
    v_add_f32 v20, v20, v22
    v_add_f32 v20, v20, v21
    v_lshlrev_b32 v21, 16, v9
    v_and_b32 v22, 0xffff0000, v9
    v_lshlrev_b32 v23, 16, v13
    v_and_b32 v24, 0xffff0000, v13
    v_mul_f32 v21, v21, v23
    v_mul_f32 v22, v22, v24
    v_cvt_pk_bf16_f32 v21, v21, v22
    v_lshlrev_b32 v22, 16, v21
    v_and_b32 v21, 0xffff0000, v21
    v_add_f32 v20, v20, v22
    v_add_f32 v20, v20, v21
    v_lshlrev_b32 v21, 16, v10
    v_and_b32 v22, 0xffff0000, v10
    v_lshlrev_b32 v23, 16, v14
    v_and_b32 v24, 0xffff0000, v14
    v_mul_f32 v21, v21, v23
    v_mul_f32 v22, v22, v24
    v_cvt_pk_bf16_f32 v21, v21, v22
    v_lshlrev_b32 v22, 16, v21
    v_and_b32 v21, 0xffff0000, v21
    v_add_f32 v20, v20, v22
    v_add_f32 v20, v20, v21
    v_lshlrev_b32 v21, 16, v11
    v_and_b32 v22, 0xffff0000, v11
    v_lshlrev_b32 v23, 16, v15
    v_and_b32 v24, 0xffff0000, v15
    v_mul_f32 v21, v21, v23
    v_mul_f32 v22, v22, v24
    v_cvt_pk_bf16_f32 v21, v21, v22
    v_lshlrev_b32 v22, 16, v21
    v_and_b32 v21, 0xffff0000, v21
    v_add_f32 v20, v20, v22
    v_add_f32 v20, v20, v21
    v_mov_b32 v21, v20
    v_mov_b32 v22, v20
    s_nop 1
    v_permlane32_swap_b32 v21, v22
    s_nop 1
    v_add_f32 v21, v21, v22
    s_nop 0
    v_mov_b32 v22, v21
    s_nop 1
    v_permlane16_swap_b32 v21, v22
    s_nop 1
    v_add_f32 v21, v21, v22
    s_nop 1
    v_add_f32_dpp v21, v21, v21 row_ror:1 row_mask:0xf bank_mask:0xf
    s_nop 1
    v_add_f32_dpp v21, v21, v21 row_ror:2 row_mask:0xf bank_mask:0xf
    s_nop 1
    v_add_f32_dpp v21, v21, v21 row_ror:4 row_mask:0xf bank_mask:0xf
    s_nop 1
    v_add_f32_dpp v21, v21, v21 row_ror:8 row_mask:0xf bank_mask:0xf
    s_nop 1
    v_cvt_pk_bf16_f32 v21, v21, v21
    v_lshlrev_b32 v21, 16, v21
    v_mul_f32 v21, 0xbfb8aa3b, v21
    v_exp_f32 v21, v21
    s_nop 0
    v_add_f32 v21, 1.0, v21
    v_rcp_f32 v21, v21
    s_nop 0
    v_cvt_pk_bf16_f32 v21, v21, v21
    v_lshlrev_b32 v22, 16, v21
    v_sub_f32 v23, 1.0, v22
    v_cvt_pk_bf16_f32 v23, v23, v23
    v_lshlrev_b32 v23, 16, v23
    ds_write_b64 v17, v[22:23] offset:2624
    s_waitcnt lgkmcnt(0)
    s_bfe_u32 s50, s50, 0x50003
    s_cmp_eq_u32 s50, 31
    s_cselect_b32 s50, 0, s50
    s_add_u32 s50, s50, 1
    s_lshl_b32 s50, s50, 3
    s_getreg_b32 s51, hwreg(HW_REG_XCC_ID)
    s_and_b32 s51, s51, 7
    s_or_b32 s51, s51, s50
    s_branch L_XMID
L_X7:
    v_lshlrev_b32 v3, 4, v0
    v_mov_b32 v8, 0
    v_mov_b32 v9, 0
    v_mov_b32 v10, 0
    v_mov_b32 v11, 0
    ds_write_b128 v3, v[8:11] offset:2048
    s_waitcnt lgkmcnt(0)
    s_barrier
    s_bfe_u32 s50, s50, 0x50003
    s_cmp_eq_u32 s50, 31
    s_cselect_b32 s50, 0, s50
    s_add_u32 s50, s50, 1
    s_lshl_b32 s50, s50, 3
    s_getreg_b32 s51, hwreg(HW_REG_XCC_ID)
    s_and_b32 s51, s51, 7
    s_or_b32 s51, s51, s50
L_XMID:
    s_lshl_b32 s46, s61, 2
    v_mov_b32 v36, s46
    s_lshl_b32 s46, s29, 4
    s_lshl_b32 s47, s28, 1
    s_add_u32 s46, s46, s47
    s_lshr_b32 s47, s61, 1
    s_add_u32 s46, s46, s47
    s_lshl_b32 s46, s46, 12
    s_and_b32 s47, s61, 1
    s_lshl_b32 s47, s47, 9
    s_add_u32 s46, s46, s47
    s_add_u32 s60, s46, 4096
    v_lshlrev_b32 v3, 3, v0
    v_lshrrev_b32 v37, 5, v0
    v_lshlrev_b32 v37, 7, v37
    v_bfe_u32 v38, v0, 1, 3
    v_lshl_add_u32 v37, v38, 4, v37
    v_bfe_u32 v38, v0, 4, 1
    v_lshl_add_u32 v37, v38, 3, v37
    v_and_b32 v38, 1, v0
    v_lshl_add_u32 v37, v38, 2, v37
    s_lshl_b32 s46, s61, 8
    s_add_u32 s46, s46, 0
    v_add_u32 v37, s46, v37
QPOLL_5:
    buffer_load_dwordx2 v[40:41], v3, s[40:43], s60 offen offset:0 sc1
    buffer_load_dwordx2 v[42:43], v3, s[40:43], s60 offen offset:1024 sc1
    buffer_load_dwordx2 v[44:45], v3, s[40:43], s60 offen offset:2048 sc1
    buffer_load_dwordx2 v[46:47], v3, s[40:43], s60 offen offset:3072 sc1
    ds_read_b128 v[52:55], v17 offset:2560
    s_waitcnt vmcnt(0) lgkmcnt(0)
    s_cmp_lg_u32 s63, 0
    s_cbranch_scc1 QSL_6
    v_xor_b32 v40, s51, v40
    v_xor_b32 v41, s51, v41
    v_xor_b32 v42, s51, v42
    v_xor_b32 v43, s51, v43
    v_xor_b32 v44, s51, v44
    v_xor_b32 v45, s51, v45
    v_xor_b32 v46, s51, v46
    v_xor_b32 v47, s51, v47
    v_or_b32 v38, v40, v41
    v_or3_b32 v38, v38, v42, v43
    v_or3_b32 v38, v38, v44, v45
    v_or3_b32 v38, v38, v46, v47
    v_and_b32 v38, 0xff, v38
    s_branch QCK_7
QSL_6:
    v_and_b32 v39, 0xf8, v40
    v_msad_u8 v38, v39, s50, 0
    v_and_b32 v40, v18, v40
    v_and_b32 v39, 0xf8, v41
    v_msad_u8 v38, v39, s50, v38
    v_and_b32 v41, v18, v41
    v_and_b32 v39, 0xf8, v42
    v_msad_u8 v38, v39, s50, v38
    v_and_b32 v42, v18, v42
    v_and_b32 v39, 0xf8, v43
    v_msad_u8 v38, v39, s50, v38
    v_and_b32 v43, v18, v43
    v_and_b32 v39, 0xf8, v44
    v_msad_u8 v38, v39, s50, v38
    v_and_b32 v44, v18, v44
    v_and_b32 v39, 0xf8, v45
    v_msad_u8 v38, v39, s50, v38
    v_and_b32 v45, v18, v45
    v_and_b32 v39, 0xf8, v46
    v_msad_u8 v38, v39, s50, v38
    v_and_b32 v46, v18, v46
    v_and_b32 v39, 0xf8, v47
    v_msad_u8 v38, v39, s50, v38
    v_and_b32 v47, v18, v47
QCK_7:
    v_cmp_ne_u32 vcc, 0, v38
    s_add_u32 s54, s54, 1
    s_cmp_ge_u32 s54, 200000
    s_cbranch_scc1 QDN_8
    s_cmp_eq_u64 vcc, 0
    s_cbranch_scc1 QDN_8
    v_min_u32 v52, v52, v53
    v_min3_u32 v52, v52, v54, v55
    s_nop 0
    v_readfirstlane_b32 s46, v52
    s_nop 0
    s_cmp_lt_u32 s46, 4
    s_cbranch_scc1 QNX_9
    s_mov_b32 s63, 1
    s_cmp_lg_u32 s62, 0
    s_cbranch_scc1 RP_10
    s_mov_b32 s62, 1
    buffer_store_dwordx4 v[20:23], v35, s[40:43], s55 offen sc1
    buffer_store_dwordx4 v[24:27], v35, s[40:43], s55 offen offset:128 sc1
RP_10:
QNX_9:
    s_sleep 4
    s_branch QPOLL_5
QDN_8:
    v_add_f32 v40, v40, v42
    v_add_f32 v41, v41, v43
    v_add_f32 v44, v44, v46
    v_add_f32 v45, v45, v47
    v_add_f32 v40, v40, v44
    v_add_f32 v41, v41, v45
    v_cvt_pk_bf16_f32 v40, v40, v41
    ds_write_b32 v37, v40
    v_mov_b32 v38, s63
    ds_write_b32 v36, v38 offset:2592
    v_mov_b32 v38, 1
    s_waitcnt lgkmcnt(0)
    ds_write_b32 v36, v38 offset:2576
    v_xor_b32 v39, v6, v5
    v_lshlrev_b32 v39, 4, v39
    v_lshl_add_u32 v39, v5, 9, v39
    s_lshl_b32 s46, s61, 15
    s_add_u32 s46, s46, 8192
    v_add_u32 v48, s46, v39
    v_xor_b32 v49, 64, v48
    v_xor_b32 v50, 0x80, v48
    v_xor_b32 v51, 0xc0, v48
    v_and_b32 v39, 1, v5
    v_lshlrev_b32 v39, 9, v39
    v_lshl_add_u32 v39, v6, 4, v39
XW_11:
    ds_read_b128 v[40:43], v17 offset:2576
    ds_read_b128 v[52:55], v17 offset:2560
    s_waitcnt lgkmcnt(0)
    v_min_u32 v40, v40, v41
    v_min3_u32 v40, v40, v42, v43
    s_nop 0
    v_readfirstlane_b32 s46, v40
    s_nop 0
    s_cmp_ge_u32 s46, 1
    s_cbranch_scc1 XWD_12
    v_min_u32 v52, v52, v53
    v_min3_u32 v52, v52, v54, v55
    s_nop 0
    v_readfirstlane_b32 s46, v52
    s_nop 0
    s_cmp_lt_u32 s46, 4
    s_cbranch_scc1 XWN_13
    s_cmp_lg_u32 s62, 0
    s_cbranch_scc1 RP_14
    s_mov_b32 s62, 1
    buffer_store_dwordx4 v[20:23], v35, s[40:43], s55 offen sc1
    buffer_store_dwordx4 v[24:27], v35, s[40:43], s55 offen offset:128 sc1
RP_14:
XWN_13:
    s_sleep 1
    s_branch XW_11
XWD_12:
    ds_read_b128 v[40:43], v17 offset:2592
    s_waitcnt lgkmcnt(0)
    v_or_b32 v40, v40, v41
    v_or3_b32 v40, v40, v42, v43
    s_nop 0
    v_readfirstlane_b32 s63, v40
    s_nop 0
    s_cmp_eq_u32 s63, 0
    s_cbranch_scc1 NRP_15
    s_cmp_lg_u32 s62, 0
    s_cbranch_scc1 RP_16
    s_mov_b32 s62, 1
    buffer_store_dwordx4 v[20:23], v35, s[40:43], s55 offen sc1
    buffer_store_dwordx4 v[24:27], v35, s[40:43], s55 offen offset:128 sc1
RP_16:
NRP_15:
    ds_read_b128 v[64:67], v39 offset:0
    ds_read_b128 v[68:71], v39 offset:64
    ds_read_b128 v[72:75], v39 offset:128
    ds_read_b128 v[76:79], v39 offset:192
    ds_read_b128 v[80:83], v39 offset:256
    ds_read_b128 v[84:87], v39 offset:320
    ds_read_b128 v[88:91], v39 offset:384
    ds_read_b128 v[92:95], v39 offset:448
LW_17:
    ds_read_b32 v40, v36 offset:2560
    s_waitcnt lgkmcnt(0)
    v_readfirstlane_b32 s46, v40
    s_nop 0
    s_cmp_ge_u32 s46, 2
    s_cbranch_scc1 LWD_18
    s_sleep 1
    s_branch LW_17
LWD_18:
    ds_read_b128 v[96:99], v48 offset:0
    ds_read_b128 v[100:103], v48 offset:8192
    ds_read_b128 v[104:107], v48 offset:16384
    ds_read_b128 v[108:111], v48 offset:24576
    ds_read_b128 v[112:115], v49 offset:0
    ds_read_b128 v[116:119], v49 offset:8192
    ds_read_b128 v[120:123], v49 offset:16384
    ds_read_b128 v[124:127], v49 offset:24576
    s_waitcnt lgkmcnt(7)
    v_mfma_f32_16x16x32_bf16 v[224:227], v[64:67], v[96:99], 0
    ds_read_b128 v[128:131], v50 offset:0
    s_waitcnt lgkmcnt(7)
    v_mfma_f32_16x16x32_bf16 v[228:231], v[64:67], v[100:103], 0
    ds_read_b128 v[132:135], v50 offset:8192
    s_waitcnt lgkmcnt(7)
    v_mfma_f32_16x16x32_bf16 v[232:235], v[64:67], v[104:107], 0
    ds_read_b128 v[136:139], v50 offset:16384
    s_waitcnt lgkmcnt(7)
    v_mfma_f32_16x16x32_bf16 v[236:239], v[64:67], v[108:111], 0
    ds_read_b128 v[140:143], v50 offset:24576
    s_waitcnt lgkmcnt(7)
    v_mfma_f32_16x16x32_bf16 v[224:227], v[68:71], v[112:115], v[224:227]
    ds_read_b128 v[144:147], v51 offset:0
    s_waitcnt lgkmcnt(7)
    v_mfma_f32_16x16x32_bf16 v[228:231], v[68:71], v[116:119], v[228:231]
    ds_read_b128 v[148:151], v51 offset:8192
    s_waitcnt lgkmcnt(7)
    v_mfma_f32_16x16x32_bf16 v[232:235], v[68:71], v[120:123], v[232:235]
    ds_read_b128 v[152:155], v51 offset:16384
    s_waitcnt lgkmcnt(7)
    v_mfma_f32_16x16x32_bf16 v[236:239], v[68:71], v[124:127], v[236:239]
    ds_read_b128 v[156:159], v51 offset:24576
    s_waitcnt lgkmcnt(7)
    v_mfma_f32_16x16x32_bf16 v[224:227], v[72:75], v[128:131], v[224:227]
    ds_read_b128 v[160:163], v48 offset:256
    s_waitcnt lgkmcnt(7)
    v_mfma_f32_16x16x32_bf16 v[228:231], v[72:75], v[132:135], v[228:231]
    ds_read_b128 v[164:167], v48 offset:8448
    s_waitcnt lgkmcnt(7)
    v_mfma_f32_16x16x32_bf16 v[232:235], v[72:75], v[136:139], v[232:235]
    ds_read_b128 v[168:171], v48 offset:16640
    s_waitcnt lgkmcnt(7)
    v_mfma_f32_16x16x32_bf16 v[236:239], v[72:75], v[140:143], v[236:239]
    ds_read_b128 v[172:175], v48 offset:24832
    s_waitcnt lgkmcnt(7)
    v_mfma_f32_16x16x32_bf16 v[224:227], v[76:79], v[144:147], v[224:227]
    ds_read_b128 v[176:179], v49 offset:256
    s_waitcnt lgkmcnt(7)
    v_mfma_f32_16x16x32_bf16 v[228:231], v[76:79], v[148:151], v[228:231]
    ds_read_b128 v[180:183], v49 offset:8448
    s_waitcnt lgkmcnt(7)
    v_mfma_f32_16x16x32_bf16 v[232:235], v[76:79], v[152:155], v[232:235]
    ds_read_b128 v[184:187], v49 offset:16640
    s_waitcnt lgkmcnt(7)
    v_mfma_f32_16x16x32_bf16 v[236:239], v[76:79], v[156:159], v[236:239]
    ds_read_b128 v[188:191], v49 offset:24832
    s_waitcnt lgkmcnt(7)
    v_mfma_f32_16x16x32_bf16 v[224:227], v[80:83], v[160:163], v[224:227]
    ds_read_b128 v[192:195], v50 offset:256
    s_waitcnt lgkmcnt(7)
    v_mfma_f32_16x16x32_bf16 v[228:231], v[80:83], v[164:167], v[228:231]
    ds_read_b128 v[196:199], v50 offset:8448
    s_waitcnt lgkmcnt(7)
    v_mfma_f32_16x16x32_bf16 v[232:235], v[80:83], v[168:171], v[232:235]
    ds_read_b128 v[200:203], v50 offset:16640
    s_waitcnt lgkmcnt(7)
    v_mfma_f32_16x16x32_bf16 v[236:239], v[80:83], v[172:175], v[236:239]
    ds_read_b128 v[204:207], v50 offset:24832
    s_waitcnt lgkmcnt(7)
    v_mfma_f32_16x16x32_bf16 v[224:227], v[84:87], v[176:179], v[224:227]
    ds_read_b128 v[208:211], v51 offset:256
    s_waitcnt lgkmcnt(7)
    v_mfma_f32_16x16x32_bf16 v[228:231], v[84:87], v[180:183], v[228:231]
    ds_read_b128 v[212:215], v51 offset:8448
    s_waitcnt lgkmcnt(7)
    v_mfma_f32_16x16x32_bf16 v[232:235], v[84:87], v[184:187], v[232:235]
    ds_read_b128 v[216:219], v51 offset:16640
    s_waitcnt lgkmcnt(7)
    v_mfma_f32_16x16x32_bf16 v[236:239], v[84:87], v[188:191], v[236:239]
    ds_read_b128 v[220:223], v51 offset:24832
    s_waitcnt lgkmcnt(7)
    v_mfma_f32_16x16x32_bf16 v[224:227], v[88:91], v[192:195], v[224:227]
    s_waitcnt lgkmcnt(6)
    v_mfma_f32_16x16x32_bf16 v[228:231], v[88:91], v[196:199], v[228:231]
    s_waitcnt lgkmcnt(5)
    v_mfma_f32_16x16x32_bf16 v[232:235], v[88:91], v[200:203], v[232:235]
    s_waitcnt lgkmcnt(4)
    v_mfma_f32_16x16x32_bf16 v[236:239], v[88:91], v[204:207], v[236:239]
    s_waitcnt lgkmcnt(3)
    v_mfma_f32_16x16x32_bf16 v[224:227], v[92:95], v[208:211], v[224:227]
    s_waitcnt lgkmcnt(2)
    v_mfma_f32_16x16x32_bf16 v[228:231], v[92:95], v[212:215], v[228:231]
    s_waitcnt lgkmcnt(1)
    v_mfma_f32_16x16x32_bf16 v[232:235], v[92:95], v[216:219], v[232:235]
    s_waitcnt lgkmcnt(0)
    v_mfma_f32_16x16x32_bf16 v[236:239], v[92:95], v[220:223], v[236:239]
    v_cmp_eq_u32 s[64:65], 1, v6
    v_cmp_eq_u32 s[66:67], 2, v6
    v_cmp_eq_u32 s[68:69], 3, v6
    s_nop 5
    v_cndmask_b32 v40, v224, v228, s[64:65]
    v_cndmask_b32 v40, v40, v232, s[66:67]
    v_cndmask_b32 v40, v40, v236, s[68:69]
    v_cndmask_b32 v41, v225, v229, s[64:65]
    v_cndmask_b32 v41, v41, v233, s[66:67]
    v_cndmask_b32 v41, v41, v237, s[68:69]
    v_cvt_pk_bf16_f32 v41, v40, v41
    v_lshlrev_b32 v40, 16, v41
    v_and_b32 v41, 0xffff0000, v41
    v_mov_b32 v42, v40
    v_mov_b32 v43, v41
    s_nop 1
    v_permlane32_swap_b32 v42, v43
    s_nop 1
    v_max_f32 v42, v42, v43
    s_nop 0
    v_mov_b32 v43, v42
    s_nop 1
    v_permlane16_swap_b32 v42, v43
    s_nop 1
    v_max_f32 v42, v42, v43
    s_nop 1
    v_max_f32_dpp v42, v42, v42 row_ror:1 row_mask:0xf bank_mask:0xf
    s_nop 1
    v_max_f32_dpp v42, v42, v42 row_ror:2 row_mask:0xf bank_mask:0xf
    s_nop 1
    v_max_f32_dpp v42, v42, v42 row_ror:4 row_mask:0xf bank_mask:0xf
    s_nop 1
    v_max_f32_dpp v42, v42, v42 row_ror:8 row_mask:0xf bank_mask:0xf
    s_nop 1
    v_lshrrev_b32 v44, 5, v0
    v_lshlrev_b32 v44, 2, v44
    s_lshl_b32 s46, s61, 3
    v_add_u32 v44, s46, v44
    ds_write_b32 v44, v42 offset:2640
    v_mov_b32 v38, 2
    s_waitcnt lgkmcnt(0)
    ds_write_b32 v36, v38 offset:2576
LW_19:
    ds_read_b128 v[52:55], v17 offset:2576
    s_waitcnt lgkmcnt(0)
    v_min_u32 v52, v52, v53
    v_min3_u32 v52, v52, v54, v55
    s_nop 0
    v_readfirstlane_b32 s46, v52
    s_nop 0
    s_cmp_ge_u32 s46, 2
    s_cbranch_scc1 LWD_20
    s_sleep 1
    s_branch LW_19
LWD_20:
    ds_read_b128 v[52:55], v17 offset:2640
    ds_read_b128 v[56:59], v17 offset:2656
    s_waitcnt lgkmcnt(0)
    v_max_f32 v52, v52, v54
    v_max3_f32 v52, v52, v56, v58
    v_max_f32 v53, v53, v55
    v_max3_f32 v53, v53, v57, v59
    s_mov_b32 s47, 0x3db8aa3b
    v_sub_f32 v40, v40, v52
    v_sub_f32 v41, v41, v53
    v_mul_f32 v40, s47, v40
    v_mul_f32 v41, s47, v41
    v_exp_f32 v40, v40
    v_exp_f32 v41, v41
    s_nop 0
    v_cvt_pk_bf16_f32 v45, v40, v41
    s_lshl_b32 s46, s61, 7
    s_add_u32 s46, s46, 1024
    v_lshlrev_b32 v46, 1, v0
    v_add_u32 v46, s46, v46
    ds_write_b16 v46, v45
    ds_write_b16_d16_hi v46, v45 offset:512
    v_mov_b32 v42, v40
    v_mov_b32 v43, v41
    s_nop 1
    v_permlane32_swap_b32 v42, v43
    s_nop 1
    v_add_f32 v42, v42, v43
    s_nop 0
    v_mov_b32 v43, v42
    s_nop 1
    v_permlane16_swap_b32 v42, v43
    s_nop 1
    v_add_f32 v42, v42, v43
    s_nop 1
    v_add_f32_dpp v42, v42, v42 row_ror:1 row_mask:0xf bank_mask:0xf
    s_nop 1
    v_add_f32_dpp v42, v42, v42 row_ror:2 row_mask:0xf bank_mask:0xf
    s_nop 1
    v_add_f32_dpp v42, v42, v42 row_ror:4 row_mask:0xf bank_mask:0xf
    s_nop 1
    v_add_f32_dpp v42, v42, v42 row_ror:8 row_mask:0xf bank_mask:0xf
    s_nop 1
    ds_write_b32 v44, v42 offset:2672
    v_mov_b32 v38, 3
    s_waitcnt lgkmcnt(0)
    ds_write_b32 v36, v38 offset:2576
    s_cmp_eq_u32 s3, 5
    s_cbranch_scc1 L_Y5
    s_cmp_eq_u32 s3, 6
    s_cbranch_scc1 L_Y6
    s_cmp_eq_u32 s3, 7
    s_cbranch_scc1 L_Y7
L_PROJ:
    s_cmp_eq_u32 s29, 7
    s_cbranch_scc1 L_PTOUCH
    s_mov_b32 s36, s12
    s_mov_b32 s37, s13
    s_mov_b32 s38, 3670016
    s_mov_b32 s39, 0x20000
    s_lshr_b32 s75, s61, 1
    s_lshl_b32 s72, s28, 2
    s_add_u32 s72, s72, s30
    v_mul_u32_u24 v36, 57344, v2
    v_lshrrev_b32 v37, 2, v1
    v_lshl_add_u32 v36, v37, 11, v36
    v_and_b32 v37, 3, v1
    v_lshl_add_u32 v36, v37, 4, v36
    s_lshl_b32 s46, s29, 13
    s_lshl_b32 s47, s72, 6
    s_add_u32 s46, s46, s47
    s_add_u32 s32, s46, 1576960
    s_add_u32 s33, s32, 4096
    v_lshlrev_b32 v37, 5, v0
    s_lshl_b32 s46, s75, 11
    v_add_u32 v60, s46, v37
    s_add_u32 s46, s75, 1
    s_cmp_ge_u32 s46, 3
    s_cselect_b32 s46, 0, s46
    s_lshl_b32 s47, s46, 11
    v_add_u32 v61, s47, v37
    s_add_u32 s46, s46, 1
    s_cmp_ge_u32 s46, 3
    s_cselect_b32 s46, 0, s46
    s_lshl_b32 s47, s46, 11
    v_add_u32 v62, s47, v37
    v_mov_b32 v63, 1
    v_and_b32 v3, 3, v2
    v_mul_u32_u24 v3, 14336, v3
    v_lshrrev_b32 v4, 2, v2
    v_mul_u32_u24 v4, 896, v4
    v_add_u32 v3, v3, v4
    v_lshl_add_u32 v3, v1, 4, v3
    s_lshl_b32 s45, s72, 1
    s_add_u32 s45, s45, s75
    s_mul_i32 s46, s45, 57344
    s_lshl_b32 s47, s29, 7
    s_add_u32 s76, s46, s47
    s_add_u32 s77, s76, 3584
    s_add_u32 s78, s76, 7168
    s_add_u32 s79, s76, 10752
    v_lshlrev_b32 v4, 11, v16
    v_lshl_add_u32 v4, v7, 4, v4
    s_lshl_b32 s60, s72, 14
    s_lshl_b32 s46, s75, 8
    s_add_u32 s60, s60, s46
    s_add_u32 s60, s60, 1052672
    v_lshlrev_b32 v38, 6, v16
    s_lshr_b32 s46, s72, 1
    s_lshl_b32 s46, s46, 9
    s_add_u32 s59, s46, 1044480
    v_mov_b32 v160, 0
    v_mov_b32 v161, 0
    v_mov_b32 v162, 0
    v_mov_b32 v163, 0
    v_mov_b32 v164, 0
    v_mov_b32 v165, 0
    v_mov_b32 v166, 0
    v_mov_b32 v167, 0
LW_21:
    ds_read_b128 v[40:43], v17 offset:2560
    s_waitcnt lgkmcnt(0)
    v_min_u32 v40, v40, v41
    v_min3_u32 v40, v40, v42, v43
    s_nop 0
    v_readfirstlane_b32 s46, v40
    s_nop 0
    s_cmp_ge_u32 s46, 3
    s_cbranch_scc1 LWD_22
    s_sleep 1
    s_branch LW_21
LWD_22:
MLPOLL_23:
    buffer_load_dwordx4 v[168:171], v38, s[40:43], s59 offen offset:0 sc1
    buffer_load_dwordx4 v[172:175], v38, s[40:43], s59 offen offset:16 sc1
    buffer_load_dwordx4 v[176:179], v38, s[40:43], s59 offen offset:32 sc1
    buffer_load_dwordx4 v[180:183], v38, s[40:43], s59 offen offset:48 sc1
    s_waitcnt vmcnt(0)
    v_xor_b32 v168, s50, v168
    v_xor_b32 v169, s50, v169
    v_xor_b32 v170, s50, v170
    v_xor_b32 v171, s50, v171
    v_xor_b32 v172, s50, v172
    v_xor_b32 v173, s50, v173
    v_xor_b32 v174, s50, v174
    v_xor_b32 v175, s50, v175
    v_xor_b32 v176, s50, v176
    v_xor_b32 v177, s50, v177
    v_xor_b32 v178, s50, v178
    v_xor_b32 v179, s50, v179
    v_xor_b32 v180, s50, v180
    v_xor_b32 v181, s50, v181
    v_xor_b32 v182, s50, v182
    v_xor_b32 v183, s50, v183
    v_or_b32 v40, v168, v169
    v_or3_b32 v40, v40, v170, v171
    v_or3_b32 v40, v40, v172, v173
    v_or3_b32 v40, v40, v174, v175
    v_or3_b32 v40, v40, v176, v177
    v_or3_b32 v40, v40, v178, v179
    v_or3_b32 v40, v40, v180, v181
    v_or3_b32 v40, v40, v182, v183
    v_and_b32 v40, 0xff, v40
    v_cmp_ne_u32 vcc, 0, v40
    s_add_u32 s54, s54, 1
    s_cmp_ge_u32 s54, 200000
    s_cbranch_scc1 PD_24
    s_cmp_eq_u64 vcc, 0
    s_cbranch_scc1 PD_24
    s_sleep 8
    s_branch MLPOLL_23
PD_24:
    v_bfe_u32 v169, v169, 8, 8
    v_and_or_b32 v168, v168, v18, v169
    v_bfe_u32 v173, v173, 8, 8
    v_and_or_b32 v172, v172, v18, v173
    v_bfe_u32 v177, v177, 8, 8
    v_and_or_b32 v176, v176, v18, v177
    v_bfe_u32 v181, v181, 8, 8
    v_and_or_b32 v180, v180, v18, v181
    v_max_f32 v40, v168, v172
    v_max3_f32 v40, v40, v176, v180
    s_mov_b32 s47, 0x3db8aa3b
    v_sub_f32 v52, v168, v40
    v_mul_f32 v52, s47, v52
    v_exp_f32 v52, v52
    v_sub_f32 v53, v172, v40
    v_mul_f32 v53, s47, v53
    v_exp_f32 v53, v53
    v_sub_f32 v54, v176, v40
    v_mul_f32 v54, s47, v54
    v_exp_f32 v54, v54
    v_sub_f32 v55, v180, v40
    v_mul_f32 v55, s47, v55
    v_exp_f32 v55, v55
    s_nop 0
    v_mul_f32 v41, v52, v170
    v_fmac_f32 v41, v53, v174
    v_fmac_f32 v41, v54, v178
    v_fmac_f32 v41, v55, v182
    v_rcp_f32 v41, v41
    s_nop 0
    v_mul_f32 v41, v41, v171
    v_mul_f32 v52, v52, v41
    v_mul_f32 v53, v53, v41
    v_mul_f32 v54, v54, v41
    v_mul_f32 v55, v55, v41
LW_25:
    ds_read_b128 v[40:43], v17 offset:2560
    s_waitcnt lgkmcnt(0)
    v_min_u32 v40, v40, v41
    v_min3_u32 v40, v40, v42, v43
    s_nop 0
    v_readfirstlane_b32 s46, v40
    s_nop 0
    s_cmp_ge_u32 s46, 4
    s_cbranch_scc1 LWD_26
    s_sleep 1
    s_branch LW_25
LWD_26:
    buffer_load_dwordx4 v[64:67], v3, s[36:39], s76 offen offset:0 nt
    buffer_load_dwordx4 v[68:71], v3, s[36:39], s77 offen offset:0 nt
    buffer_load_dwordx4 v[72:75], v3, s[36:39], s78 offen offset:0 nt
    buffer_load_dwordx4 v[76:79], v3, s[36:39], s79 offen offset:0 nt
    buffer_load_dwordx4 v[80:83], v3, s[36:39], s76 offen offset:1792 nt
    buffer_load_dwordx4 v[84:87], v3, s[36:39], s77 offen offset:1792 nt
    buffer_load_dwordx4 v[88:91], v3, s[36:39], s78 offen offset:1792 nt
    buffer_load_dwordx4 v[92:95], v3, s[36:39], s79 offen offset:1792 nt
    s_mov_b32 s44, 0
LW_27:
    ds_read_b128 v[40:43], v17 offset:2560
    s_waitcnt lgkmcnt(0)
    v_min_u32 v40, v40, v41
    v_min3_u32 v40, v40, v42, v43
    s_nop 0
    v_readfirstlane_b32 s46, v40
    s_nop 0
    s_cmp_ge_u32 s46, 5
    s_cbranch_scc1 LWD_28
    s_sleep 1
    s_branch LW_27
LWD_28:
    s_mov_b64 s[64:65], -1
    s_mov_b64 s[66:67], -1
    s_mov_b64 s[68:69], -1
    s_mov_b64 s[70:71], -1
    buffer_load_dwordx4 v[128:131], v4, s[40:43], s60 offen offset:0 sc1
    buffer_load_dwordx4 v[132:135], v4, s[40:43], s60 offen offset:128 sc1
    buffer_load_dwordx4 v[136:139], v4, s[40:43], s60 offen offset:512 sc1
    buffer_load_dwordx4 v[140:143], v4, s[40:43], s60 offen offset:640 sc1
    buffer_load_dwordx4 v[144:147], v4, s[40:43], s60 offen offset:1024 sc1
    buffer_load_dwordx4 v[148:151], v4, s[40:43], s60 offen offset:1152 sc1
    buffer_load_dwordx4 v[152:155], v4, s[40:43], s60 offen offset:1536 sc1
    buffer_load_dwordx4 v[156:159], v4, s[40:43], s60 offen offset:1664 sc1
    s_waitcnt vmcnt(8)
    v_perm_b32 v96, v68, v64, s52
    v_perm_b32 v100, v68, v64, s53
    v_perm_b32 v104, v69, v65, s52
    v_perm_b32 v108, v69, v65, s53
    v_perm_b32 v112, v70, v66, s52
    v_perm_b32 v116, v70, v66, s53
    v_perm_b32 v120, v71, v67, s52
    v_perm_b32 v124, v71, v67, s53
    v_perm_b32 v97, v76, v72, s52
    v_perm_b32 v101, v76, v72, s53
    v_perm_b32 v105, v77, v73, s52
    v_perm_b32 v109, v77, v73, s53
    v_perm_b32 v113, v78, v74, s52
    v_perm_b32 v117, v78, v74, s53
    v_perm_b32 v121, v79, v75, s52
    v_perm_b32 v125, v79, v75, s53
    v_perm_b32 v98, v84, v80, s52
    v_perm_b32 v102, v84, v80, s53
    v_perm_b32 v106, v85, v81, s52
    v_perm_b32 v110, v85, v81, s53
    v_perm_b32 v114, v86, v82, s52
    v_perm_b32 v118, v86, v82, s53
    v_perm_b32 v122, v87, v83, s52
    v_perm_b32 v126, v87, v83, s53
    v_perm_b32 v99, v92, v88, s52
    v_perm_b32 v103, v92, v88, s53
    v_perm_b32 v107, v93, v89, s52
    v_perm_b32 v111, v93, v89, s53
    v_perm_b32 v115, v94, v90, s52
    v_perm_b32 v119, v94, v90, s53
    v_perm_b32 v123, v95, v91, s52
    v_perm_b32 v127, v95, v91, s53
PP_29:
    s_waitcnt vmcnt(0)
    s_mov_b64 exec, -1
    v_msad_u8 v28, v129, s50, 0
    v_msad_u8 v29, v137, s50, 0
    v_msad_u8 v30, v145, s50, 0
    v_msad_u8 v31, v153, s50, 0
    v_msad_u8 v28, v131, s50, v28
    v_msad_u8 v29, v139, s50, v29
    v_msad_u8 v30, v147, s50, v30
    v_msad_u8 v31, v155, s50, v31
    v_msad_u8 v28, v133, s50, v28
    v_msad_u8 v29, v141, s50, v29
    v_msad_u8 v30, v149, s50, v30
    v_msad_u8 v31, v157, s50, v31
    v_msad_u8 v28, v135, s50, v28
    v_msad_u8 v29, v143, s50, v29
    v_msad_u8 v30, v151, s50, v30
    v_msad_u8 v31, v159, s50, v31
    v_cmp_eq_u32 s[72:73], 0, v28
    v_cmp_eq_u32 s[74:75], 0, v29
    v_cmp_eq_u32 s[76:77], 0, v30
    v_cmp_eq_u32 s[78:79], 0, v31
    s_andn2_b64 exec, s[64:65], s[72:73]
    s_cbranch_execz PS_31
    buffer_load_dwordx4 v[128:131], v4, s[40:43], s60 offen offset:0 sc1
    buffer_load_dwordx4 v[132:135], v4, s[40:43], s60 offen offset:128 sc1
    s_mov_b64 s[72:73], 0
PS_31:
    s_andn2_b64 exec, s[66:67], s[74:75]
    s_cbranch_execz PS_32
    buffer_load_dwordx4 v[136:139], v4, s[40:43], s60 offen offset:512 sc1
    buffer_load_dwordx4 v[140:143], v4, s[40:43], s60 offen offset:640 sc1
    s_mov_b64 s[74:75], 0
PS_32:
    s_andn2_b64 exec, s[68:69], s[76:77]
    s_cbranch_execz PS_33
    buffer_load_dwordx4 v[144:147], v4, s[40:43], s60 offen offset:1024 sc1
    buffer_load_dwordx4 v[148:151], v4, s[40:43], s60 offen offset:1152 sc1
    s_mov_b64 s[76:77], 0
PS_33:
    s_andn2_b64 exec, s[70:71], s[78:79]
    s_cbranch_execz PS_34
    buffer_load_dwordx4 v[152:155], v4, s[40:43], s60 offen offset:1536 sc1
    buffer_load_dwordx4 v[156:159], v4, s[40:43], s60 offen offset:1664 sc1
    s_mov_b64 s[78:79], 0
PS_34:
    s_and_b64 exec, s[64:65], s[72:73]
    s_cbranch_execz PS_35
    v_xor_b32 v128, s50, v128
    v_xor_b32 v129, s50, v129
    v_xor_b32 v130, s50, v130
    v_xor_b32 v131, s50, v131
    v_xor_b32 v132, s50, v132
    v_xor_b32 v133, s50, v133
    v_xor_b32 v134, s50, v134
    v_xor_b32 v135, s50, v135
    v_or_b32 v28, v128, v129
    v_or3_b32 v28, v28, v130, v131
    v_or3_b32 v28, v28, v132, v133
    v_or3_b32 v28, v28, v134, v135
    v_and_b32 v28, 0xff, v28
    v_cmpx_eq_u32 s[72:73], 0, v28
    v_fmac_f32 v160, v52, v128
    v_fmac_f32 v161, v52, v129
    v_fmac_f32 v162, v52, v130
    v_fmac_f32 v163, v52, v131
    v_fmac_f32 v164, v52, v132
    v_fmac_f32 v165, v52, v133
    v_fmac_f32 v166, v52, v134
    v_fmac_f32 v167, v52, v135
    s_andn2_b64 s[64:65], s[64:65], s[72:73]
PS_35:
    s_and_b64 exec, s[66:67], s[74:75]
    s_cbranch_execz PS_36
    v_xor_b32 v136, s50, v136
    v_xor_b32 v137, s50, v137
    v_xor_b32 v138, s50, v138
    v_xor_b32 v139, s50, v139
    v_xor_b32 v140, s50, v140
    v_xor_b32 v141, s50, v141
    v_xor_b32 v142, s50, v142
    v_xor_b32 v143, s50, v143
    v_or_b32 v29, v136, v137
    v_or3_b32 v29, v29, v138, v139
    v_or3_b32 v29, v29, v140, v141
    v_or3_b32 v29, v29, v142, v143
    v_and_b32 v29, 0xff, v29
    v_cmpx_eq_u32 s[74:75], 0, v29
    v_fmac_f32 v160, v53, v136
    v_fmac_f32 v161, v53, v137
    v_fmac_f32 v162, v53, v138
    v_fmac_f32 v163, v53, v139
    v_fmac_f32 v164, v53, v140
    v_fmac_f32 v165, v53, v141
    v_fmac_f32 v166, v53, v142
    v_fmac_f32 v167, v53, v143
    s_andn2_b64 s[66:67], s[66:67], s[74:75]
PS_36:
    s_and_b64 exec, s[68:69], s[76:77]
    s_cbranch_execz PS_37
    v_xor_b32 v144, s50, v144
    v_xor_b32 v145, s50, v145
    v_xor_b32 v146, s50, v146
    v_xor_b32 v147, s50, v147
    v_xor_b32 v148, s50, v148
    v_xor_b32 v149, s50, v149
    v_xor_b32 v150, s50, v150
    v_xor_b32 v151, s50, v151
    v_or_b32 v30, v144, v145
    v_or3_b32 v30, v30, v146, v147
    v_or3_b32 v30, v30, v148, v149
    v_or3_b32 v30, v30, v150, v151
    v_and_b32 v30, 0xff, v30
    v_cmpx_eq_u32 s[76:77], 0, v30
    v_fmac_f32 v160, v54, v144
    v_fmac_f32 v161, v54, v145
    v_fmac_f32 v162, v54, v146
    v_fmac_f32 v163, v54, v147
    v_fmac_f32 v164, v54, v148
    v_fmac_f32 v165, v54, v149
    v_fmac_f32 v166, v54, v150
    v_fmac_f32 v167, v54, v151
    s_andn2_b64 s[68:69], s[68:69], s[76:77]
PS_37:
    s_and_b64 exec, s[70:71], s[78:79]
    s_cbranch_execz PS_38
    v_xor_b32 v152, s50, v152
    v_xor_b32 v153, s50, v153
    v_xor_b32 v154, s50, v154
    v_xor_b32 v155, s50, v155
    v_xor_b32 v156, s50, v156
    v_xor_b32 v157, s50, v157
    v_xor_b32 v158, s50, v158
    v_xor_b32 v159, s50, v159
    v_or_b32 v31, v152, v153
    v_or3_b32 v31, v31, v154, v155
    v_or3_b32 v31, v31, v156, v157
    v_or3_b32 v31, v31, v158, v159
    v_and_b32 v31, 0xff, v31
    v_cmpx_eq_u32 s[78:79], 0, v31
    v_fmac_f32 v160, v55, v152
    v_fmac_f32 v161, v55, v153
    v_fmac_f32 v162, v55, v154
    v_fmac_f32 v163, v55, v155
    v_fmac_f32 v164, v55, v156
    v_fmac_f32 v165, v55, v157
    v_fmac_f32 v166, v55, v158
    v_fmac_f32 v167, v55, v159
    s_andn2_b64 s[70:71], s[70:71], s[78:79]
PS_38:
    s_or_b64 s[48:49], s[64:65], s[66:67]
    s_or_b64 s[48:49], s[48:49], s[68:69]
    s_or_b64 s[48:49], s[48:49], s[70:71]
    s_cbranch_scc0 PPD_30
    s_add_u32 s54, s54, 1
    s_cmp_lt_u32 s54, 200000
    s_cbranch_scc1 PP_29
PPD_30:
    s_mov_b64 exec, -1
    v_cvt_pk_bf16_f32 v8, v160, v161
    v_cvt_pk_bf16_f32 v9, v162, v163
    v_cvt_pk_bf16_f32 v10, v164, v165
    v_cvt_pk_bf16_f32 v11, v166, v167
L_COMB:
    s_nop 1
    v_mfma_f32_16x16x32_bf16 v[224:227], v[8:11], v[96:99], 0
    s_nop 0
    s_nop 0
    v_mfma_f32_16x16x32_bf16 v[228:231], v[8:11], v[100:103], 0
    s_nop 0
    s_nop 0
    v_mfma_f32_16x16x32_bf16 v[232:235], v[8:11], v[104:107], 0
    s_nop 0
    s_nop 0
    v_mfma_f32_16x16x32_bf16 v[236:239], v[8:11], v[108:111], 0
    v_cndmask_b32 v40, v226, v225, s[56:57]
    v_cndmask_b32 v20, v224, v227, s[56:57]
    v_mfma_f32_16x16x32_bf16 v[240:243], v[8:11], v[112:115], 0
    v_cndmask_b32 v41, v230, v229, s[56:57]
    v_cndmask_b32 v21, v228, v231, s[56:57]
    v_mfma_f32_16x16x32_bf16 v[244:247], v[8:11], v[116:119], 0
    v_cndmask_b32 v42, v234, v233, s[56:57]
    v_cndmask_b32 v22, v232, v235, s[56:57]
    v_mfma_f32_16x16x32_bf16 v[248:251], v[8:11], v[120:123], 0
    v_cndmask_b32 v43, v238, v237, s[56:57]
    v_cndmask_b32 v23, v236, v239, s[56:57]
    v_mfma_f32_16x16x32_bf16 v[252:255], v[8:11], v[124:127], 0
    v_cndmask_b32 v44, v242, v241, s[56:57]
    v_cndmask_b32 v24, v240, v243, s[56:57]
    v_cndmask_b32 v45, v246, v245, s[56:57]
    v_cndmask_b32 v25, v244, v247, s[56:57]
    s_nop 0
    v_cndmask_b32 v46, v250, v249, s[56:57]
    v_cndmask_b32 v26, v248, v251, s[56:57]
    s_nop 0
    v_cndmask_b32 v47, v254, v253, s[56:57]
    v_cndmask_b32 v27, v252, v255, s[56:57]
    v_add_f32_dpp v20, v40, v20 row_ror:8 row_mask:0xf bank_mask:0xf
    v_add_f32_dpp v21, v41, v21 row_ror:8 row_mask:0xf bank_mask:0xf
    v_add_f32_dpp v22, v42, v22 row_ror:8 row_mask:0xf bank_mask:0xf
    v_add_f32_dpp v23, v43, v23 row_ror:8 row_mask:0xf bank_mask:0xf
    v_add_f32_dpp v24, v44, v24 row_ror:8 row_mask:0xf bank_mask:0xf
    v_add_f32_dpp v25, v45, v25 row_ror:8 row_mask:0xf bank_mask:0xf
    v_add_f32_dpp v26, v46, v26 row_ror:8 row_mask:0xf bank_mask:0xf
    v_add_f32_dpp v27, v47, v27 row_ror:8 row_mask:0xf bank_mask:0xf
L_COMB2:
    ds_write_b128 v60, v[20:23] offset:8192
    ds_write_b128 v60, v[24:27] offset:8208
    s_mov_b64 exec, 1
    ds_add_rtn_u32 v28, v17, v63 offset:2608
    s_mov_b64 exec, -1
    ds_read_b128 v[40:43], v61 offset:8192
    ds_read_b128 v[44:47], v61 offset:8208
    ds_read_b128 v[48:51], v62 offset:8192
    ds_read_b128 v[52:55], v62 offset:8208
    s_waitcnt lgkmcnt(4)
    v_readfirstlane_b32 s46, v28
    s_nop 0
    s_cmp_lg_u32 s46, 2
    s_cbranch_scc1 L_NOTLAST
    s_waitcnt lgkmcnt(0)
    v_pk_add_f32 v[40:41], v[40:41], v[48:49]
    v_pk_add_f32 v[42:43], v[42:43], v[50:51]
    v_pk_add_f32 v[44:45], v[44:45], v[52:53]
    v_pk_add_f32 v[46:47], v[46:47], v[54:55]
    v_pk_add_f32 v[20:21], v[20:21], v[40:41]
    v_pk_add_f32 v[22:23], v[22:23], v[42:43]
    v_pk_add_f32 v[24:25], v[24:25], v[44:45]
    v_pk_add_f32 v[26:27], v[26:27], v[46:47]
    v_and_or_b32 v20, v20, v18, s50
    v_and_or_b32 v21, v21, v18, s50
    v_and_or_b32 v22, v22, v18, s50
    v_and_or_b32 v23, v23, v18, s50
    v_and_or_b32 v24, v24, v18, s50
    v_and_or_b32 v25, v25, v18, s50
    v_and_or_b32 v26, v26, v18, s50
    v_and_or_b32 v27, v27, v18, s50
    buffer_store_dwordx4 v[20:23], v36, s[40:43], s32 offen sc1
    buffer_store_dwordx4 v[24:27], v36, s[40:43], s33 offen sc1
    s_waitcnt vmcnt(0)
    v_mov_b32 v28, 4
    ds_write_b32 v17, v28 offset:2608
L_NOTLAST:
    s_cmp_eq_u32 s3, 7
    s_cbranch_scc1 L_RED
L_YEND:
    s_endpgm
L_PTOUCH:
    s_branch L_YEND
L_Y5:
    s_cmp_ge_u32 s31, 28
    s_cbranch_scc1 L_END
    s_lshl_b32 s46, s31, 14
    s_lshl_b32 s47, s29, 11
    s_add_u32 s46, s46, s47
    s_add_u32 s60, s46, 528384
    s_lshl_b32 s46, s31, 11
    s_lshl_b32 s47, s29, 8
    s_add_u32 s46, s46, s47
    s_add_u32 s59, s46, 987136
    v_lshlrev_b32 v3, 2, v0
    ds_read_b64 v[52:53], v17 offset:2624
HPOLL_39:
    buffer_load_dword v40, v3, s[40:43], s60 offen offset:0 sc1
    buffer_load_dword v41, v3, s[40:43], s60 offen offset:256 sc1
    buffer_load_dword v42, v3, s[40:43], s60 offen offset:512 sc1
    buffer_load_dword v43, v3, s[40:43], s60 offen offset:768 sc1
    buffer_load_dword v44, v3, s[40:43], s60 offen offset:1024 sc1
    buffer_load_dword v45, v3, s[40:43], s60 offen offset:1280 sc1
    buffer_load_dword v46, v3, s[40:43], s60 offen offset:1536 sc1
    s_waitcnt vmcnt(0) lgkmcnt(0)
    v_xor_b32 v40, s50, v40
    v_xor_b32 v41, s50, v41
    v_xor_b32 v42, s50, v42
    v_xor_b32 v43, s50, v43
    v_xor_b32 v44, s50, v44
    v_xor_b32 v45, s50, v45
    v_xor_b32 v46, s50, v46
    v_or3_b32 v39, v40, v41, v42
    v_or3_b32 v39, v39, v43, v44
    v_or3_b32 v39, v39, v45, v46
    v_and_b32 v39, 0xff, v39
    v_cmp_ne_u32 vcc, 0, v39
    s_add_u32 s54, s54, 1
    s_cmp_ge_u32 s54, 200000
    s_cbranch_scc1 PD_40
    s_cmp_eq_u64 vcc, 0
    s_cbranch_scc1 PD_40
    s_sleep 8
    s_branch HPOLL_39
PD_40:
    v_add_f32 v40, v40, v41
    v_add_f32 v42, v42, v43
    v_add_f32 v44, v44, v45
    v_add_f32 v40, v40, v42
    v_add_f32 v44, v44, v46
    v_add_f32 v40, v40, v44
    v_cvt_pk_bf16_f32 v40, v40, v40
    v_lshlrev_b32 v40, 16, v40
    v_mul_f32 v41, 0xbfb8aa3b, v40
    v_exp_f32 v41, v41
    s_nop 0
    v_add_f32 v41, 1.0, v41
    v_rcp_f32 v41, v41
    s_nop 0
    v_mul_f32 v40, v40, v41
    v_cvt_pk_bf16_f32 v40, v40, v40
    v_lshlrev_b32 v40, 16, v40
    v_mul_f32 v40, v40, v53
    v_and_or_b32 v40, v40, v18, s50
    v_bfe_u32 v3, v0, 2, 3
    v_lshlrev_b32 v3, 5, v3
    v_lshrrev_b32 v4, 5, v0
    v_lshl_add_u32 v3, v4, 4, v3
    v_and_b32 v4, 3, v0
    v_lshl_add_u32 v3, v4, 2, v3
    s_cmp_lg_u32 s63, 0
    s_cbranch_scc1 SL_41
    buffer_store_dword v40, v3, s[40:43], s59 offen
    s_branch SD_42
SL_41:
    buffer_store_dword v40, v3, s[40:43], s59 offen sc1
SD_42:
    s_endpgm
L_Y6:
LW_43:
    ds_read_b128 v[40:43], v17 offset:2576
    s_waitcnt lgkmcnt(0)
    v_min_u32 v40, v40, v41
    v_min3_u32 v40, v40, v42, v43
    s_nop 0
    v_readfirstlane_b32 s46, v40
    s_nop 0
    s_cmp_ge_u32 s46, 3
    s_cbranch_scc1 LWD_44
    s_sleep 1
    s_branch LW_43
LWD_44:
    ds_read_b128 v[40:43], v17 offset:2672
    ds_read_b128 v[44:47], v17 offset:2688
    ds_read_b64 v[60:61], v17 offset:2624
    s_waitcnt lgkmcnt(0)
    v_add_f32 v40, v40, v42
    v_add_f32 v44, v44, v46
    v_add_f32 v40, v40, v44
    v_add_f32 v41, v41, v43
    v_add_f32 v45, v45, v47
    v_add_f32 v41, v41, v45
    v_and_b32 v42, 1, v0
    v_cmp_eq_u32 vcc, 1, v42
    s_nop 1
    v_cndmask_b32 v44, v52, v53, vcc
    v_cndmask_b32 v46, v40, v41, vcc
    v_lshlrev_b32 v45, 8, v44
    v_mov_b32 v47, v60
    v_and_or_b32 v44, v44, v18, s50
    v_and_or_b32 v45, v45, v18, s50
    v_and_or_b32 v46, v46, v18, s50
    v_and_or_b32 v47, v47, v18, s50
    s_lshl_b32 s46, s28, 10
    s_lshl_b32 s47, s29, 6
    s_add_u32 s46, s46, s47
    s_lshl_b32 s47, s30, 4
    s_add_u32 s46, s46, s47
    s_add_u32 s59, s46, 1044480
    v_lshlrev_b32 v3, 9, v0
    v_cmp_gt_u32 vcc, 2, v0
    s_nop 1
    v_cndmask_b32 v4, v19, v3, vcc
    s_cmp_lg_u32 s63, 0
    s_cbranch_scc1 SL_45
    buffer_store_dwordx4 v[44:47], v4, s[40:43], s59 offen
    s_branch SD_46
SL_45:
    buffer_store_dwordx4 v[44:47], v4, s[40:43], s59 offen sc1
SD_46:
    s_branch L_PROJ
L_Y7:
    s_cmp_eq_u32 s29, 7
    s_cbranch_scc1 L_END
    s_mov_b32 s75, 2
    s_lshl_b32 s72, s28, 2
    s_add_u32 s72, s72, s30
    v_mul_u32_u24 v36, 57344, v2
    v_lshrrev_b32 v37, 2, v1
    v_lshl_add_u32 v36, v37, 11, v36
    v_and_b32 v37, 3, v1
    v_lshl_add_u32 v36, v37, 4, v36
    s_lshl_b32 s46, s29, 13
    s_lshl_b32 s47, s72, 6
    s_add_u32 s46, s46, s47
    s_add_u32 s32, s46, 1576960
    s_add_u32 s33, s32, 4096
    v_lshlrev_b32 v37, 5, v0
    s_lshl_b32 s46, s75, 11
    v_add_u32 v60, s46, v37
    s_add_u32 s46, s75, 1
    s_cmp_ge_u32 s46, 3
    s_cselect_b32 s46, 0, s46
    s_lshl_b32 s47, s46, 11
    v_add_u32 v61, s47, v37
    s_add_u32 s46, s46, 1
    s_cmp_ge_u32 s46, 3
    s_cselect_b32 s46, 0, s46
    s_lshl_b32 s47, s46, 11
    v_add_u32 v62, s47, v37
    v_mov_b32 v63, 1
    s_cmp_ge_u32 s31, 28
    s_cbranch_scc1 L_Y7Z
    s_mov_b32 s36, s18
    s_mov_b32 s37, s19
    s_mov_b32 s38, 1605632
    s_mov_b32 s39, 0x20000
    v_mul_u32_u24 v3, 7168, v2
    v_lshl_add_u32 v3, v1, 4, v3
    s_mul_i32 s46, s31, 57344
    s_lshl_b32 s47, s29, 7
    s_add_u32 s58, s46, s47
    s_add_u32 s59, s58, 3584
    v_lshlrev_b32 v4, 8, v16
    v_lshl_add_u32 v4, v7, 5, v4
    s_lshl_b32 s60, s31, 11
    s_add_u32 s60, s60, 987136
LW_47:
    ds_read_b128 v[40:43], v17 offset:2560
    s_waitcnt lgkmcnt(0)
    v_min_u32 v40, v40, v41
    v_min3_u32 v40, v40, v42, v43
    s_nop 0
    v_readfirstlane_b32 s46, v40
    s_nop 0
    s_cmp_ge_u32 s46, 3
    s_cbranch_scc1 LWD_48
    s_sleep 1
    s_branch LW_47
LWD_48:
H2POLL_49:
    buffer_load_dwordx4 v[40:43], v4, s[40:43], s60 offen sc1
    buffer_load_dwordx4 v[44:47], v4, s[40:43], s60 offen offset:16 sc1
    s_waitcnt vmcnt(0)
    v_xor_b32 v40, s50, v40
    v_xor_b32 v41, s50, v41
    v_xor_b32 v42, s50, v42
    v_xor_b32 v43, s50, v43
    v_xor_b32 v44, s50, v44
    v_xor_b32 v45, s50, v45
    v_xor_b32 v46, s50, v46
    v_xor_b32 v47, s50, v47
    v_or_b32 v39, v40, v41
    v_or3_b32 v39, v39, v42, v43
    v_or3_b32 v39, v39, v44, v45
    v_or3_b32 v39, v39, v46, v47
    v_and_b32 v39, 0xff, v39
    v_cmp_ne_u32 vcc, 0, v39
    s_add_u32 s54, s54, 1
    s_cmp_ge_u32 s54, 200000
    s_cbranch_scc1 PD_50
    s_cmp_eq_u64 vcc, 0
    s_cbranch_scc1 PD_50
    s_sleep 8
    s_branch H2POLL_49
PD_50:
    v_cvt_pk_bf16_f32 v8, v40, v41
    v_cvt_pk_bf16_f32 v9, v42, v43
    v_cvt_pk_bf16_f32 v10, v44, v45
    v_cvt_pk_bf16_f32 v11, v46, v47
LW_51:
    ds_read_b128 v[40:43], v17 offset:2560
    s_waitcnt lgkmcnt(0)
    v_min_u32 v40, v40, v41
    v_min3_u32 v40, v40, v42, v43
    s_nop 0
    v_readfirstlane_b32 s46, v40
    s_nop 0
    s_cmp_ge_u32 s46, 4
    s_cbranch_scc1 LWD_52
    s_sleep 1
    s_branch LW_51
LWD_52:
    buffer_load_dwordx4 v[64:67], v3, s[36:39], s58 offen offset:0 nt
    buffer_load_dwordx4 v[68:71], v3, s[36:39], s58 offen offset:896 nt
    buffer_load_dwordx4 v[72:75], v3, s[36:39], s58 offen offset:1792 nt
    buffer_load_dwordx4 v[76:79], v3, s[36:39], s58 offen offset:2688 nt
    buffer_load_dwordx4 v[80:83], v3, s[36:39], s59 offen offset:0 nt
    buffer_load_dwordx4 v[84:87], v3, s[36:39], s59 offen offset:896 nt
    buffer_load_dwordx4 v[88:91], v3, s[36:39], s59 offen offset:1792 nt
    buffer_load_dwordx4 v[92:95], v3, s[36:39], s59 offen offset:2688 nt
    s_waitcnt vmcnt(0)
    v_perm_b32 v96, v68, v64, s52
    v_perm_b32 v100, v68, v64, s53
    v_perm_b32 v104, v69, v65, s52
    v_perm_b32 v108, v69, v65, s53
    v_perm_b32 v112, v70, v66, s52
    v_perm_b32 v116, v70, v66, s53
    v_perm_b32 v120, v71, v67, s52
    v_perm_b32 v124, v71, v67, s53
    v_perm_b32 v97, v76, v72, s52
    v_perm_b32 v101, v76, v72, s53
    v_perm_b32 v105, v77, v73, s52
    v_perm_b32 v109, v77, v73, s53
    v_perm_b32 v113, v78, v74, s52
    v_perm_b32 v117, v78, v74, s53
    v_perm_b32 v121, v79, v75, s52
    v_perm_b32 v125, v79, v75, s53
    v_perm_b32 v98, v84, v80, s52
    v_perm_b32 v102, v84, v80, s53
    v_perm_b32 v106, v85, v81, s52
    v_perm_b32 v110, v85, v81, s53
    v_perm_b32 v114, v86, v82, s52
    v_perm_b32 v118, v86, v82, s53
    v_perm_b32 v122, v87, v83, s52
    v_perm_b32 v126, v87, v83, s53
    v_perm_b32 v99, v92, v88, s52
    v_perm_b32 v103, v92, v88, s53
    v_perm_b32 v107, v93, v89, s52
    v_perm_b32 v111, v93, v89, s53
    v_perm_b32 v115, v94, v90, s52
    v_perm_b32 v119, v94, v90, s53
    v_perm_b32 v123, v95, v91, s52
    v_perm_b32 v127, v95, v91, s53
    s_branch L_COMB
L_Y7Z:
    v_mov_b32 v20, 0
    v_mov_b32 v21, 0
    v_mov_b32 v22, 0
    v_mov_b32 v23, 0
    v_mov_b32 v24, 0
    v_mov_b32 v25, 0
    v_mov_b32 v26, 0
    v_mov_b32 v27, 0
    s_branch L_COMB2
L_RED:
    s_mov_b32 s36, s22
    s_mov_b32 s37, s23
    s_mov_b32 s38, 7168
    s_mov_b32 s39, 0x20000
    v_lshlrev_b32 v37, 4, v0
    s_mul_i32 s46, s28, 7
    s_add_u32 s46, s46, s29
    s_lshl_b32 s46, s46, 13
    s_lshl_b32 s47, s30, 11
    s_add_u32 s60, s46, s47
    s_add_u32 s60, s60, 1576960
    v_and_b32 v3, 3, v0
    v_lshlrev_b32 v3, 3, v3
    v_and_b32 v4, 1, v6
    v_lshl_add_u32 v3, v4, 1, v3
    v_lshrrev_b32 v4, 1, v6
    v_add_u32 v3, v3, v4
    v_lshlrev_b32 v3, 1, v3
    v_cmp_gt_u32 vcc, 4, v5
    s_nop 1
    v_cndmask_b32 v3, v19, v3, vcc
    s_mul_i32 s46, s28, 896
    s_lshl_b32 s47, s29, 7
    s_add_u32 s46, s46, s47
    s_and_b32 s47, s30, 1
    s_lshl_b32 s47, s47, 6
    s_add_u32 s46, s46, s47
    s_lshr_b32 s47, s30, 1
    s_lshl_b32 s47, s47, 3
    s_add_u32 s59, s46, s47
LW_53:
    ds_read_b32 v44, v17 offset:2608
    s_waitcnt lgkmcnt(0)
    v_readfirstlane_b32 s46, v44
    s_nop 0
    s_cmp_ge_u32 s46, 4
    s_cbranch_scc1 LWD_54
    s_sleep 1
    s_branch LW_53
LWD_54:
    v_mov_b32 v40, 0
    v_mov_b32 v41, 0
    v_mov_b32 v42, 0
    v_mov_b32 v43, 0
    s_mov_b64 s[64:65], -1
    s_mov_b64 s[66:67], -1
    buffer_load_dwordx4 v[64:67], v37, s[40:43], s60 offen offset:0 sc1
    buffer_load_dwordx4 v[68:71], v37, s[40:43], s60 offen offset:1024 sc1
PP_55:
    s_waitcnt vmcnt(0)
    s_mov_b64 exec, -1
    v_msad_u8 v44, v64, s50, 0
    v_msad_u8 v45, v68, s50, 0
    v_msad_u8 v44, v65, s50, v44
    v_msad_u8 v45, v69, s50, v45
    v_msad_u8 v44, v66, s50, v44
    v_msad_u8 v45, v70, s50, v45
    v_msad_u8 v44, v67, s50, v44
    v_msad_u8 v45, v71, s50, v45
    v_cmp_eq_u32 s[72:73], 0, v44
    v_cmp_eq_u32 s[74:75], 0, v45
    s_andn2_b64 exec, s[64:65], s[72:73]
    s_cbranch_execz PS_57
    s_mov_b64 exec, s[64:65]
    buffer_load_dwordx4 v[64:67], v37, s[40:43], s60 offen offset:0 sc1
    s_mov_b64 s[72:73], 0
PS_57:
    s_andn2_b64 exec, s[66:67], s[74:75]
    s_cbranch_execz PS_58
    s_mov_b64 exec, s[66:67]
    buffer_load_dwordx4 v[68:71], v37, s[40:43], s60 offen offset:1024 sc1
    s_mov_b64 s[74:75], 0
PS_58:
    s_and_b64 exec, s[64:65], s[72:73]
    s_cbranch_execz PS_59
    v_xor_b32 v64, s50, v64
    v_xor_b32 v65, s50, v65
    v_xor_b32 v66, s50, v66
    v_xor_b32 v67, s50, v67
    v_or_b32 v44, v64, v65
    v_or3_b32 v44, v44, v66, v67
    v_and_b32 v44, 0xff, v44
    v_cmpx_eq_u32 s[72:73], 0, v44
    v_add_f32 v40, v40, v64
    v_add_f32 v41, v41, v65
    v_add_f32 v42, v42, v66
    v_add_f32 v43, v43, v67
    s_andn2_b64 s[64:65], s[64:65], s[72:73]
PS_59:
    s_and_b64 exec, s[66:67], s[74:75]
    s_cbranch_execz PS_60
    v_xor_b32 v68, s50, v68
    v_xor_b32 v69, s50, v69
    v_xor_b32 v70, s50, v70
    v_xor_b32 v71, s50, v71
    v_or_b32 v45, v68, v69
    v_or3_b32 v45, v45, v70, v71
    v_and_b32 v45, 0xff, v45
    v_cmpx_eq_u32 s[74:75], 0, v45
    v_add_f32 v40, v40, v68
    v_add_f32 v41, v41, v69
    v_add_f32 v42, v42, v70
    v_add_f32 v43, v43, v71
    s_andn2_b64 s[66:67], s[66:67], s[74:75]
PS_60:
    s_or_b64 s[48:49], s[64:65], s[66:67]
    s_cbranch_scc0 PPD_56
    s_add_u32 s54, s54, 1
    s_cmp_lt_u32 s54, 200000
    s_cbranch_scc1 PP_55
PPD_56:
    s_mov_b64 exec, -1
    s_nop 1
    v_permlane32_swap_b32 v40, v41
    v_permlane32_swap_b32 v42, v43
    s_nop 1
    v_add_f32 v40, v40, v41
    v_add_f32 v42, v42, v43
    s_nop 1
    v_permlane16_swap_b32 v40, v42
    s_nop 1
    v_add_f32 v40, v40, v42
    s_nop 1
    v_add_f32_dpp v40, v40, v40 row_ror:4 row_mask:0xf bank_mask:0xf
    s_nop 1
    v_add_f32_dpp v40, v40, v40 row_ror:8 row_mask:0xf bank_mask:0xf
    v_cvt_pk_bf16_f32 v40, v40, v40
    buffer_store_short v40, v3, s[36:39], s59 offen
    s_or_b32 s46, s28, s29
    s_or_b32 s46, s46, s30
    s_cbranch_scc1 L_END
    v_mov_b32 v40, s50
    v_cmp_eq_u32 vcc, 0, v0
    s_nop 1
    v_cndmask_b32 v3, v19, v17, vcc
    buffer_store_dword v40, v3, s[40:43], 0 offen offset:0
L_END:
    s_endpgm
.section .rodata,"a"
.p2align 6
.amdhsa_kernel gated_mix__sliding_block_cached__dense_activation_silu__decode_kernel
  .amdhsa_next_free_vgpr 256
  .amdhsa_next_free_sgpr 100
  .amdhsa_accum_offset 256
  .amdhsa_group_segment_fixed_size 0
  .amdhsa_kernarg_size 96
  .amdhsa_user_sgpr_count 2
  .amdhsa_user_sgpr_kernarg_segment_ptr 1
  .amdhsa_system_sgpr_workgroup_id_x 1
  .amdhsa_float_denorm_mode_32 3
.end_amdhsa_kernel
```
